```python
import torch

def _softmax(x, axis=-1):
    return torch.softmax(x, dim=axis)
def _gelu(x):
    return torch.nn.functional.gelu(x, approximate="tanh")
def _silu(x):
    return torch.nn.functional.silu(x)
def _sigmoid(x):
    return torch.sigmoid(x)
def _layernorm(x, axis=-1, eps=1e-5):
    m = x.mean(dim=axis, keepdim=True)
    v = x.var(dim=axis, keepdim=True, unbiased=False)
    return (x - m) / torch.sqrt(v + eps)
def _scatter_add(tgt, idx, src, axis=0):
    return tgt.clone().index_add_(axis, idx, src)
def _segment_sum(src, seg, n):
    out = torch.zeros((n,) + src.shape[1:], dtype=src.dtype)
    return out.index_add_(0, seg, src)
def _pad(x, pw):
    flat = tuple(v for pair in reversed(pw) for v in pair)
    return torch.nn.functional.pad(x, flat)

kernel_name = 'recurrent_scan__gqa_block_cached__glu_gated_glu__decode'

def setup_inputs():

    _w = (lambda a: (lambda t: t.to(torch.bfloat16) if t.is_floating_point() else t)(torch.as_tensor(a)))
    def _A_setup():
        B, Sq, D = 1, 1, 512
        Hq, Hkv, Sk, Dh = 32, 8, 65536, 128
        assert Hq % Hkv == 0, (Hq, Hkv)
        return {
            "x": _w((lambda *s: torch.randn(*s, dtype=torch.bfloat16) * 0.05)(B, Sq, D)),
            "k_cache": _w((lambda *s: torch.randn(*s, dtype=torch.bfloat16) * 1.6)(B, Hkv, Sk, Dh)),
            "v_cache": _w((lambda *s: torch.randn(*s, dtype=torch.bfloat16) * 0.8)(B, Hkv, Sk, Dh)),
            "wq": _w((lambda *s: torch.randn(*s, dtype=torch.bfloat16) * 1.6)(D, Hq * Dh) * (D ** -0.5)),
            "wo": _w((lambda *s: torch.randn(*s, dtype=torch.bfloat16) * 0.8)(Hq * Dh, D) * ((Hq * Dh) ** -0.5)),
        }
    _A_in = _A_setup()

    def _B_setup():
        B, S, D, F = 1, 1, 512, 1792
        return {
            "x": _w((lambda *s: torch.randn(*s, dtype=torch.bfloat16) * 0.05)(B, S, D)),
            "w_gate": _w((lambda *s: torch.randn(*s, dtype=torch.bfloat16) * 0.8)(D, F)),
            "w_up": _w((lambda *s: torch.randn(*s, dtype=torch.bfloat16) * 0.2)(D, F)),
            "w_down": _w((lambda *s: torch.randn(*s, dtype=torch.bfloat16) * 0.2)(F, D)),
        }
    _B_in = _B_setup()

    return {
        "A_x": _A_in["x"],
        "A_k_cache": _A_in["k_cache"],
        "A_v_cache": _A_in["v_cache"],
        "A_wq": _A_in["wq"],
        "A_wo": _A_in["wo"],
        "B_x": _B_in["x"],
        "B_w_gate": _B_in["w_gate"],
        "B_w_up": _B_in["w_up"],
        "B_w_down": _B_in["w_down"],
    }

def reference(A_x, A_k_cache, A_v_cache, A_wq, A_wo, B_x, B_w_gate, B_w_up, B_w_down):
    def _A_ref(x, k_cache, v_cache, wq, wo):
        B, Sq, D = x.shape
        Hq, Dh = 32, 128
        Hkv = k_cache.shape[1]
        rep = Hq // Hkv
        q = (lambda x, *d: x.permute(*d))((x @ wq).reshape(B, Sq, Hq, Dh), 0, 2, 1, 3)
        k = (lambda x, n, axis: torch.repeat_interleave(x, n, dim=axis))(k_cache, rep, axis=1)
        v = (lambda x, n, axis: torch.repeat_interleave(x, n, dim=axis))(v_cache, rep, axis=1)
        scores = torch.einsum("bhqd,bhkd->bhqk", q, k) * (Dh ** -0.5)
        p = _softmax(scores, axis=-1)
        o = torch.einsum("bhqk,bhkd->bhqd", p, v)
        return (lambda x, *d: x.permute(*d))(o, 0, 2, 1, 3).reshape(B, Sq, Hq * Dh) @ wo

    def _B_ref(x, w_gate, w_up, w_down):
        g = torch.einsum("bsd,df->bsf", x, w_gate)
        u = torch.einsum("bsd,df->bsf", x, w_up)
        h = _sigmoid(g) * u
        return torch.einsum("bsf,fd->bsd", h, w_down)

    x = A_x
    xn = _layernorm(x, axis=-1)
    s = _A_ref(xn, A_k_cache, A_v_cache, A_wq, A_wo)
    g = _silu(_B_ref(xn, B_w_gate, B_w_up, B_w_down))
    return x + s * g
```

```asm
; @launch grid=(256,1,1) block=(256,1,1) lds=20480
.amdgcn_target "amdgcn-amd-amdhsa--gfx950"
.text
.globl recurrent_scan__gqa_block_cached__glu_gated_glu__decode_kernel
.p2align 8
.type recurrent_scan__gqa_block_cached__glu_gated_glu__decode_kernel,@function
recurrent_scan__gqa_block_cached__glu_gated_glu__decode_kernel:
  s_load_dwordx2 s[28:29], s[0:1], 8
  s_load_dwordx16 s[4:19], s[0:1], 0
  s_load_dwordx8 s[20:27], s[0:1], 64
  s_cmpk_ge_u32 s2, 256
  s_cbranch_scc1 L_done
  s_and_b32 s49, s2, 7
  s_lshr_b32 s50, s2, 3
  s_getpc_b64 s[78:79]
L_pc:
  v_and_b32 v8, 7, v0
  v_lshl_add_u32 v8, s50, 3, v8
  v_lshlrev_b32 v8, 7, v8
  v_min_u32 v8, L_codeend-L_pc-4, v8
  global_load_dword v9, v8, s[78:79]
  s_and_b32 s56, s2, 64
  s_lshl_b32 s51, s56, 8
  s_and_b32 s56, s2, 128
  s_lshl_b32 s56, s56, 10
  s_xor_b32 s51, s51, s56
  s_and_b32 s56, s2, 128
  s_lshl_b32 s56, s56, 12
  s_xor_b32 s51, s51, s56
  s_and_b32 s56, s2, 8
  s_lshl_b32 s56, s56, 13
  s_xor_b32 s51, s51, s56
  s_and_b32 s56, s2, 48
  s_lshl_b32 s56, s56, 16
  s_xor_b32 s51, s51, s56
  s_and_b32 s56, s2, 4
  s_lshl_b32 s56, s56, 20
  s_xor_b32 s51, s51, s56
  s_and_b32 s56, s2, 7
  s_lshl_b32 s56, s56, 24
  s_xor_b32 s51, s51, s56
  s_mov_b32 s52, s51
  v_and_b32 v146, 0x30, v0
  v_and_b32 v7, 0x8d, v0
  v_lshl_or_b32 v146, v7, 6, v146
  v_and_b32 v7, 0x42, v0
  v_lshl_or_b32 v146, v7, 9, v146
  s_lshl_b32 s30, 1, 27
  s_mov_b32 s31, 0x20000
  s_waitcnt lgkmcnt(0)
  buffer_load_dwordx4 a[0:3], v146, s[28:31], s51 offen offset:0 nt
  buffer_load_dwordx4 a[4:7], v146, s[28:31], s51 offen offset:128 nt
  buffer_load_dwordx4 a[8:11], v146, s[28:31], s51 offen offset:2048 nt
  buffer_load_dwordx4 a[12:15], v146, s[28:31], s51 offen offset:2176 nt
  s_xor_b32 s51, s52, 0x101000
  buffer_load_dwordx4 a[16:19], v146, s[28:31], s51 offen offset:0 nt
  buffer_load_dwordx4 a[20:23], v146, s[28:31], s51 offen offset:128 nt
  buffer_load_dwordx4 a[24:27], v146, s[28:31], s51 offen offset:2048 nt
  buffer_load_dwordx4 a[28:31], v146, s[28:31], s51 offen offset:2176 nt
  s_xor_b32 s51, s52, 0x810000
  v_lshrrev_b32 v63, 6, v0
  v_and_b32 v0, 63, v0
  v_lshrrev_b32 v48, 4, v0
  v_bfe_u32 v50, v0, 2, 2
  v_lshrrev_b32 v145, 1, v63
  v_lshlrev_b32 v145, 13, v145
  v_and_b32 v7, 1, v63
  v_lshl_add_u32 v145, v7, 15, v145
  v_lshl_add_u32 v7, v48, 4, v145
  v_lshl_add_u32 v7, v50, 8, v7
  v_and_b32 v49, 2, v0
  v_readfirstlane_b32 s48, v63
  s_lshl_b32 s34, 1, 27
  s_mov_b32 s35, 0x20000
  v_lshl_add_u32 v1, v49, 10, v7
  v_and_b32 v51, 1, v0
  v_lshl_add_u32 v1, v51, 10, v1
  v_and_b32 v49, 3, v0
  v_and_b32 v51, 15, v0
  v_lshlrev_b32 v2, 4, v0
  v_add_u32 v145, v145, v2
  s_mov_b32 s53, s2
  s_movk_i32 s72, 184
  s_cmp_lt_u32 s53, s72
  s_cselect_b32 s72, 128, s72
  s_cselect_b64 s[36:37], s[16:17], s[18:19]
  s_cmp_lt_u32 s53, 128
  s_cselect_b32 s72, 0, s72
  s_cselect_b64 s[36:37], s[10:11], s[36:37]
  s_movk_i32 s54, 3584
  s_cselect_b32 s54, 8192, s54
  s_sub_u32 s72, s53, s72
  s_lshr_b32 s72, s72, 1
  s_lshl_b32 s72, s72, 7
  s_and_b32 s57, s53, 1
  s_lshl_b32 s57, s57, 2
  s_add_u32 s57, s57, s48
  s_lshl_b32 s57, s57, 6
  s_mul_i32 s56, s57, s54
  s_add_u32 s72, s72, s56
  v_lshrrev_b32 v63, 3, v0
  s_lshl_b32 s57, s57, 1
  v_lshl_add_u32 v57, v63, 4, s57
  s_lshl_b32 s56, s54, 3
  v_mul_u32_u24 v58, s56, v63
  v_and_b32 v7, 7, v0
  v_lshl_add_u32 v58, v7, 4, v58
  v_mov_b32 v5, 0
  s_mov_b32 s39, 0x20000
  s_lshl_b32 s38, s54, 9
  s_cmp_lt_u32 s50, 30
  s_cselect_b32 s38, s38, 0
  global_load_dword v5, v5, s[26:27] sc1
  global_load_dwordx4 v[16:19], v2, s[4:5]
  global_load_dwordx4 v[20:23], v57, s[4:5]
  s_and_b32 s56, s53, 0xf9
  s_lshl_b32 s57, s48, 8
  s_or_b32 s56, s56, s57
  s_cmpk_lg_u32 s56, 128
  s_cbranch_scc1 L_noinit
  s_lshl_b32 s56, s53, 12
  s_add_u32 s56, s56, 0xfffc0000
  v_lshrrev_b32 v12, 2, v0
  v_lshlrev_b32 v12, 8, v12
  v_lshl_add_u32 v12, v49, 4, v12
  v_add_u32 v12, s56, v12
  v_add_u32 v13, 0x1000, v12
  v_mov_b32 v24, 0
  v_mov_b32 v25, 0
  v_mov_b32 v26, 0
  v_mov_b32 v27, 0
  global_store_dwordx4 v12, v[24:27], s[26:27] sc1
  global_store_dwordx4 v13, v[24:27], s[26:27] sc1
L_noinit:
  buffer_load_dwordx4 v[64:67], v58, s[36:39], s72 offen nt
  s_add_u32 s72, s72, s54
  buffer_load_dwordx4 v[68:71], v58, s[36:39], s72 offen nt
  s_add_u32 s72, s72, s54
  buffer_load_dwordx4 v[72:75], v58, s[36:39], s72 offen nt
  s_add_u32 s72, s72, s54
  buffer_load_dwordx4 v[76:79], v58, s[36:39], s72 offen nt
  s_add_u32 s72, s72, s54
  buffer_load_dwordx4 v[80:83], v58, s[36:39], s72 offen nt
  s_add_u32 s72, s72, s54
  buffer_load_dwordx4 v[84:87], v58, s[36:39], s72 offen nt
  s_add_u32 s72, s72, s54
  buffer_load_dwordx4 v[88:91], v58, s[36:39], s72 offen nt
  s_add_u32 s72, s72, s54
  buffer_load_dwordx4 v[92:95], v58, s[36:39], s72 offen nt
  s_mov_b64 s[44:45], s[20:21]
  s_mov_b32 s46, 1835008
  s_mov_b32 s47, 0x20000
  s_lshl_b32 s54, s50, 2
  s_add_u32 s54, s54, s48
  s_lshl_b32 s56, s54, 14
  s_lshl_b32 s57, s49, 7
  s_add_u32 s56, s56, s57
  v_lshlrev_b32 v7, 4, v7
  v_lshl_add_u32 v7, v63, 11, v7
  buffer_load_dwordx4 v[96:99], v7, s[44:47], s56 offen offset:0 nt
  buffer_load_dwordx4 v[100:103], v7, s[44:47], s56 offen offset:1024 nt
  buffer_load_dwordx4 a[32:35], v146, s[28:31], s51 offen offset:0 nt
  buffer_load_dwordx4 a[36:39], v146, s[28:31], s51 offen offset:128 nt
  buffer_load_dwordx4 a[40:43], v146, s[28:31], s51 offen offset:2048 nt
  buffer_load_dwordx4 a[44:47], v146, s[28:31], s51 offen offset:2176 nt
  s_xor_b32 s51, s52, 0x911000
  s_mov_b64 s[32:33], s[8:9]
  s_mov_b32 s16, 0x22222222
  s_mov_b32 s17, s16
  s_mov_b32 s18, 0x44444444
  s_mov_b32 s19, s18
  s_mov_b32 s10, 0x88888888
  s_mov_b32 s11, s10
  s_mov_b32 s6, 0xaaaaaaaa
  s_mov_b32 s7, s6
  s_mov_b32 s68, 0xffff0000
  s_mov_b32 s62, 0x3db504f3
  s_mov_b32 s63, 0x3fb8aa3b
  s_mov_b32 s70, 1048576
  s_mov_b64 s[40:41], s[26:27]
  s_mov_b32 s42, 0x20000000
  s_mov_b32 s43, 0x20000
  v_and_b32 v7, 1, v0
  v_lshlrev_b32 v7, 4, v7
  v_mov_b32 v4, 0xffff
  v_lshlrev_b32 v63, v7, v4
  v_cmp_gt_u32 vcc, 2, v49
  s_nop 1
  v_cndmask_b32 v3, 0, v63, vcc
  v_xor_b32 v4, v63, v3
  v_bfe_u32 v7, v0, 1, 2
  v_cmp_eq_u32 vcc, 0, v7
  s_nop 1
  v_cndmask_b32 v124, 0, v63, vcc
  v_cmp_eq_u32 vcc, 1, v7
  s_nop 1
  v_cndmask_b32 v125, 0, v63, vcc
  v_cmp_eq_u32 vcc, 2, v7
  s_nop 1
  v_cndmask_b32 v126, 0, v63, vcc
  v_cmp_eq_u32 vcc, 3, v7
  s_nop 1
  v_cndmask_b32 v127, 0, v63, vcc
  s_waitcnt vmcnt(14)
  v_readfirstlane_b32 s55, v5
  v_lshlrev_b32 v136, 16, v16
  v_and_b32 v137, s68, v16
  v_lshlrev_b32 v138, 16, v17
  v_and_b32 v139, s68, v17
  v_lshlrev_b32 v140, 16, v18
  v_and_b32 v141, s68, v18
  v_lshlrev_b32 v142, 16, v19
  v_and_b32 v143, s68, v19
  v_add_f32 v8, v136, v137
  v_add_f32 v8, v8, v138
  v_add_f32 v8, v8, v139
  v_add_f32 v8, v8, v140
  v_add_f32 v8, v8, v141
  v_add_f32 v8, v8, v142
  v_add_f32 v8, v8, v143
  s_nop 1
  v_add_f32_dpp v8, v8, v8 row_ror:8 row_mask:0xf bank_mask:0xf
  s_nop 1
  v_add_f32_dpp v8, v8, v8 row_ror:4 row_mask:0xf bank_mask:0xf
  s_nop 1
  v_add_f32_dpp v8, v8, v8 row_ror:2 row_mask:0xf bank_mask:0xf
  s_nop 1
  v_add_f32_dpp v8, v8, v8 row_ror:1 row_mask:0xf bank_mask:0xf
  v_mov_b32 v7, v8
  s_nop 1
  v_permlane16_swap_b32 v8, v7
  v_add_f32 v8, v8, v7
  v_mov_b32 v7, v8
  s_nop 1
  v_permlane32_swap_b32 v8, v7
  v_add_f32 v8, v8, v7
  v_mul_f32 v8, 0x3b000000, v8
  v_sub_f32 v136, v136, v8
  v_sub_f32 v137, v137, v8
  v_sub_f32 v138, v138, v8
  v_sub_f32 v139, v139, v8
  v_sub_f32 v140, v140, v8
  v_sub_f32 v141, v141, v8
  v_sub_f32 v142, v142, v8
  v_sub_f32 v143, v143, v8
  v_mul_f32 v12, v136, v136
  v_fmac_f32 v12, v137, v137
  v_fmac_f32 v12, v138, v138
  v_fmac_f32 v12, v139, v139
  v_fmac_f32 v12, v140, v140
  v_fmac_f32 v12, v141, v141
  v_fmac_f32 v12, v142, v142
  v_fmac_f32 v12, v143, v143
  s_nop 1
  v_add_f32_dpp v12, v12, v12 row_ror:8 row_mask:0xf bank_mask:0xf
  s_nop 1
  v_add_f32_dpp v12, v12, v12 row_ror:4 row_mask:0xf bank_mask:0xf
  s_nop 1
  v_add_f32_dpp v12, v12, v12 row_ror:2 row_mask:0xf bank_mask:0xf
  s_nop 1
  v_add_f32_dpp v12, v12, v12 row_ror:1 row_mask:0xf bank_mask:0xf
  v_mov_b32 v7, v12
  s_nop 1
  v_permlane16_swap_b32 v12, v7
  v_add_f32 v12, v12, v7
  v_mov_b32 v7, v12
  s_nop 1
  v_permlane32_swap_b32 v12, v7
  v_add_f32 v12, v12, v7
  v_mul_f32 v12, 0x3b000000, v12
  v_cvt_pk_bf16_f32 v8, v8, v12
  v_and_b32 v12, s68, v8
  v_lshlrev_b32 v8, 16, v8
  v_add_f32 v12, 0x3727c5ac, v12
  v_cvt_pk_bf16_f32 v12, v12, v12
  v_and_b32 v12, s68, v12
  v_sqrt_f32 v12, v12
  s_nop 0
  v_cvt_pk_bf16_f32 v12, v12, v12
  v_and_b32 v12, s68, v12
  v_rcp_f32 v12, v12
  v_lshlrev_b32 v136, 16, v20
  v_and_b32 v137, s68, v20
  v_lshlrev_b32 v138, 16, v21
  v_and_b32 v139, s68, v21
  v_lshlrev_b32 v140, 16, v22
  v_and_b32 v141, s68, v22
  v_lshlrev_b32 v142, 16, v23
  v_and_b32 v143, s68, v23
  v_sub_f32 v136, v136, v8
  v_sub_f32 v137, v137, v8
  v_sub_f32 v138, v138, v8
  v_sub_f32 v139, v139, v8
  v_sub_f32 v140, v140, v8
  v_sub_f32 v141, v141, v8
  v_sub_f32 v142, v142, v8
  v_sub_f32 v143, v143, v8
  v_cvt_pk_bf16_f32 v20, v136, v137
  v_cvt_pk_bf16_f32 v21, v138, v139
  v_cvt_pk_bf16_f32 v22, v140, v141
  v_cvt_pk_bf16_f32 v23, v142, v143
  v_lshlrev_b32 v136, 16, v20
  v_and_b32 v137, s68, v20
  v_lshlrev_b32 v138, 16, v21
  v_and_b32 v139, s68, v21
  v_lshlrev_b32 v140, 16, v22
  v_and_b32 v141, s68, v22
  v_lshlrev_b32 v142, 16, v23
  v_and_b32 v143, s68, v23
  v_mul_f32 v136, v136, v12
  v_mul_f32 v137, v137, v12
  v_mul_f32 v138, v138, v12
  v_mul_f32 v139, v139, v12
  v_mul_f32 v140, v140, v12
  v_mul_f32 v141, v141, v12
  v_mul_f32 v142, v142, v12
  v_mul_f32 v143, v143, v12
  v_cvt_pk_bf16_f32 v136, v136, v136
  v_cvt_pk_bf16_f32 v137, v137, v137
  v_cvt_pk_bf16_f32 v138, v138, v138
  v_cvt_pk_bf16_f32 v139, v139, v139
  v_cvt_pk_bf16_f32 v140, v140, v140
  v_cvt_pk_bf16_f32 v141, v141, v141
  v_cvt_pk_bf16_f32 v142, v142, v142
  v_cvt_pk_bf16_f32 v143, v143, v143
  v_and_b32 v156, v136, v124
  v_and_b32 v157, v136, v125
  v_and_b32 v158, v136, v126
  v_and_b32 v159, v136, v127
  v_and_b32 v160, v137, v124
  v_and_b32 v161, v137, v125
  v_and_b32 v162, v137, v126
  v_and_b32 v163, v137, v127
  v_and_b32 v164, v138, v124
  v_and_b32 v165, v138, v125
  v_and_b32 v166, v138, v126
  v_and_b32 v167, v138, v127
  v_and_b32 v168, v139, v124
  v_and_b32 v169, v139, v125
  v_and_b32 v170, v139, v126
  v_and_b32 v171, v139, v127
  v_and_b32 v172, v140, v124
  v_and_b32 v173, v140, v125
  v_and_b32 v174, v140, v126
  v_and_b32 v175, v140, v127
  v_and_b32 v176, v141, v124
  v_and_b32 v177, v141, v125
  v_and_b32 v178, v141, v126
  v_and_b32 v179, v141, v127
  v_and_b32 v180, v142, v124
  v_and_b32 v181, v142, v125
  v_and_b32 v182, v142, v126
  v_and_b32 v183, v142, v127
  v_and_b32 v184, v143, v124
  v_and_b32 v185, v143, v125
  v_and_b32 v186, v143, v126
  v_and_b32 v187, v143, v127
  buffer_load_dwordx4 a[48:51], v146, s[28:31], s51 offen offset:0 nt
  buffer_load_dwordx4 a[52:55], v146, s[28:31], s51 offen offset:128 nt
  buffer_load_dwordx4 a[56:59], v146, s[28:31], s51 offen offset:2048 nt
  buffer_load_dwordx4 a[60:63], v146, s[28:31], s51 offen offset:2176 nt
  s_xor_b32 s51, s52, 0x484000
  buffer_load_dwordx4 a[64:67], v146, s[28:31], s51 offen offset:0 nt
  buffer_load_dwordx4 a[68:71], v146, s[28:31], s51 offen offset:128 nt
  buffer_load_dwordx4 a[72:75], v146, s[28:31], s51 offen offset:2048 nt
  buffer_load_dwordx4 a[76:79], v146, s[28:31], s51 offen offset:2176 nt
  s_xor_b32 s51, s52, 0x585000
  s_waitcnt vmcnt(21)
  v_mfma_f32_16x16x32_bf16 v[8:11], v[156:159], v[64:67], 0
  s_waitcnt vmcnt(20)
  v_mfma_f32_16x16x32_bf16 v[8:11], v[160:163], v[68:71], v[8:11]
  s_waitcnt vmcnt(19)
  v_mfma_f32_16x16x32_bf16 v[8:11], v[164:167], v[72:75], v[8:11]
  s_waitcnt vmcnt(18)
  v_mfma_f32_16x16x32_bf16 v[8:11], v[168:171], v[76:79], v[8:11]
  s_waitcnt vmcnt(17)
  v_mfma_f32_16x16x32_bf16 v[8:11], v[172:175], v[80:83], v[8:11]
  s_waitcnt vmcnt(16)
  v_mfma_f32_16x16x32_bf16 v[8:11], v[176:179], v[84:87], v[8:11]
  s_waitcnt vmcnt(15)
  v_mfma_f32_16x16x32_bf16 v[8:11], v[180:183], v[88:91], v[8:11]
  s_waitcnt vmcnt(14)
  v_mfma_f32_16x16x32_bf16 v[8:11], v[184:187], v[92:95], v[8:11]
  s_add_u32 s55, s55, 0x9d3b67a5
  s_bfe_u32 s64, s55, 0x80000
  s_bfe_u32 s65, s55, 0x80008
  s_bfe_u32 s66, s55, 0x80010
  s_bfe_u32 s67, s55, 0x80018
  s_and_b32 s8, s64, 15
  s_and_b32 s9, s65, 15
  s_and_b32 s71, s66, 15
  s_and_b32 s79, s67, 15
  v_mov_b32 v52, 0xff
  s_lshl_b32 s56, s48, 9
  v_and_b32 v7, 7, v0
  v_lshl_add_u32 v7, v7, 5, s56
  v_and_b32 v63, 16, v0
  v_add_u32 v7, v7, v63
  v_and_b32 v63, 32, v0
  v_lshl_add_u32 v62, v63, 3, v7
  s_mov_b32 exec_lo, 0x00ff00ff
  s_mov_b32 exec_hi, 0xff00ff00
  ds_write_b128 v62, v[8:11] offset:0
  s_mov_b64 exec, -1
  s_waitcnt lgkmcnt(0)
  s_barrier
  s_cmp_lg_u32 s48, 0
  s_cbranch_scc1 L_pub1_done
  s_cmp_eq_u32 s38, 0
  s_cbranch_scc1 L_pub1_done
  s_mov_b64 exec, 0xffff
  s_lshr_b32 s56, s53, 1
  s_lshl_b32 s56, s56, 8
  s_and_b32 s57, s53, 1
  s_mul_i32 s57, s57, 30720
  s_add_u32 s56, s56, s57
  s_add_u32 s56, s56, 4096
  ds_read_b128 v[64:67], v2 offset:0
  ds_read_b128 v[68:71], v2 offset:256
  ds_read_b128 v[72:75], v2 offset:512
  ds_read_b128 v[76:79], v2 offset:768
  ds_read_b128 v[80:83], v2 offset:1024
  ds_read_b128 v[84:87], v2 offset:1280
  ds_read_b128 v[88:91], v2 offset:1536
  ds_read_b128 v[92:95], v2 offset:1792
  s_waitcnt lgkmcnt(0)
  v_pk_add_f32 v[64:65], v[64:65], v[80:81]
  v_pk_add_f32 v[66:67], v[66:67], v[82:83]
  v_pk_add_f32 v[68:69], v[68:69], v[84:85]
  v_pk_add_f32 v[70:71], v[70:71], v[86:87]
  v_pk_add_f32 v[72:73], v[72:73], v[88:89]
  v_pk_add_f32 v[74:75], v[74:75], v[90:91]
  v_pk_add_f32 v[76:77], v[76:77], v[92:93]
  v_pk_add_f32 v[78:79], v[78:79], v[94:95]
  v_pk_add_f32 v[64:65], v[64:65], v[72:73]
  v_pk_add_f32 v[66:67], v[66:67], v[74:75]
  v_pk_add_f32 v[68:69], v[68:69], v[76:77]
  v_pk_add_f32 v[70:71], v[70:71], v[78:79]
  v_pk_add_f32 v[64:65], v[64:65], v[68:69]
  v_pk_add_f32 v[66:67], v[66:67], v[70:71]
  v_mov_b32 v7, 15
  v_add_u32 v64, 8, v64
  v_add_u32 v65, 8, v65
  v_add_u32 v66, 8, v66
  v_add_u32 v67, 8, v67
  v_bfi_b32 v8, v7, s64, v64
  v_bfi_b32 v9, v7, s65, v65
  v_bfi_b32 v10, v7, s66, v66
  v_bfi_b32 v11, v7, s67, v67
  buffer_store_dwordx4 v[8:11], v2, s[40:43], s56 offen sc1
  s_mov_b64 exec, -1
L_pub1_done:
  s_cmp_lg_u32 s48, 1
  s_cbranch_scc1 L_nox
  s_getreg_b32 s56, hwreg(HW_REG_XCC_ID, 0, 4)
  s_lshl_b32 s59, s55, 4
  s_or_b32 s59, s59, s56
  s_lshl_b32 s56, s49, 9
  s_lshl_b32 s57, s50, 2
  s_add_u32 s56, s56, s57
  s_add_u32 s56, s56, 196608
  v_mov_b32 v7, s59
  s_mov_b64 exec, 1
  buffer_store_dword v7, v2, s[40:43], s56 offen
  s_mov_b64 exec, -1
L_nox:
  s_barrier
  buffer_load_dwordx4 a[80:83], v146, s[28:31], s51 offen offset:0 nt
  buffer_load_dwordx4 a[84:87], v146, s[28:31], s51 offen offset:128 nt
  buffer_load_dwordx4 a[88:91], v146, s[28:31], s51 offen offset:2048 nt
  buffer_load_dwordx4 a[92:95], v146, s[28:31], s51 offen offset:2176 nt
  s_xor_b32 s51, s52, 0xc94000
  buffer_load_dwordx4 a[96:99], v146, s[28:31], s51 offen offset:0 nt
  buffer_load_dwordx4 a[100:103], v146, s[28:31], s51 offen offset:128 nt
  buffer_load_dwordx4 a[104:107], v146, s[28:31], s51 offen offset:2048 nt
  buffer_load_dwordx4 a[108:111], v146, s[28:31], s51 offen offset:2176 nt
  s_xor_b32 s51, s52, 0xd95000
  v_and_b32 v7, 7, v0
  v_xor_b32 v7, v7, v48
  v_lshlrev_b32 v7, 4, v7
  v_lshl_add_u32 v53, v51, 7, v7
  s_lshl_b32 s56, s48, 11
  v_add_u32 v53, s56, v53
  v_xor_b32 v188, 64, v53
  v_lshrrev_b32 v63, 3, v0
  v_xor_b32 v54, v63, v0
  v_and_b32 v54, 7, v54
  v_lshlrev_b32 v54, 4, v54
  v_lshl_add_u32 v54, v63, 7, v54
  s_lshl_b32 s76, s49, 5
  s_add_u32 s76, s76, s50
  s_lshl_b32 s75, s76, 11
  s_add_u32 s75, s75, 524288
  s_and_b32 s56, s54, 15
  s_lshl_b32 s77, s56, 11
  s_add_u32 s77, s77, 262144
  s_mul_i32 s15, s56, 1280
  s_add_u32 s15, s15, 229376
  v_and_b32 v107, 7, v0
  v_lshlrev_b32 v107, 3, v107
  v_lshl_add_u32 v107, v63, 8, v107
  v_and_b32 v7, 62, v0
  v_lshlrev_b32 v106, 1, v7
  s_lshl_b32 s56, s56, 6
  v_add_u32 v133, s56, v7
  s_lshl_b32 s56, s48, 7
  s_add_u32 s56, s56, 12800
  v_add_u32 v191, s56, v106
  s_lshl_b32 s76, s76, 6
  s_add_u32 s76, s76, 131072
  s_lshl_b32 s56, s48, 2
  s_add_u32 s56, s56, 4224
  v_lshl_add_u32 v55, v50, 4, s56
  v_lshlrev_b32 v56, 4, v49
  v_lshl_add_u32 v59, v51, 1, v48
  v_lshlrev_b32 v59, 4, v59
  s_lshl_b32 s56, s48, 9
  v_add_u32 v59, s56, v59
  v_lshlrev_b32 v60, 11, v0
  v_lshrrev_b32 v7, 5, v0
  v_and_b32 v61, 16, v0
  v_lshlrev_b32 v61, 7, v61
  v_lshl_add_u32 v61, v7, 10, v61
  v_lshl_add_u32 v61, v51, 4, v61
  s_lshl_b32 s74, s49, 1
  s_and_b32 s56, s50, 1
  s_add_u32 s74, s74, s56
  s_lshl_b32 s73, s74, 7
  s_add_u32 s73, s73, 65536
  v_and_b32 v7, 7, v0
  v_lshlrev_b32 v7, 4, v7
  v_lshl_add_u32 v60, v63, 11, v7
  s_cmp_ge_u32 s50, 30
  s_cselect_b32 s74, s74, 999
  s_cmp_eq_u32 s48, 2
  s_cselect_b32 s74, s74, 999
  buffer_load_dwordx4 a[112:115], v146, s[28:31], s51 offen offset:0 nt
  buffer_load_dwordx4 a[116:119], v146, s[28:31], s51 offen offset:128 nt
  buffer_load_dwordx4 a[120:123], v146, s[28:31], s51 offen offset:2048 nt
  buffer_load_dwordx4 a[124:127], v146, s[28:31], s51 offen offset:2176 nt
  s_xor_b32 s51, s52, 0x20000
  buffer_load_dwordx4 a[128:131], v1, s[28:31], s51 offen offset:0 nt
  buffer_load_dwordx4 a[132:135], v1, s[28:31], s51 offen offset:64 nt
  buffer_load_dwordx4 a[136:139], v1, s[28:31], s51 offen offset:128 nt
  buffer_load_dwordx4 a[140:143], v1, s[28:31], s51 offen offset:192 nt
  s_xor_b32 s51, s52, 0x121000
  buffer_load_dwordx4 a[144:147], v146, s[28:31], s51 offen offset:0 nt
  buffer_load_dwordx4 a[148:151], v146, s[28:31], s51 offen offset:128 nt
  buffer_load_dwordx4 a[152:155], v146, s[28:31], s51 offen offset:2048 nt
  buffer_load_dwordx4 a[156:159], v146, s[28:31], s51 offen offset:2176 nt
  s_xor_b32 s51, s52, 0x830000
  v_lshlrev_b32 v57, 9, v50
  v_lshl_add_u32 v57, v48, 5, v57
  s_lshl_b32 s53, s49, 11
  s_lshl_b32 s56, s48, 7
  s_add_u32 s53, s53, s56
  s_add_u32 s53, s53, 4096
  s_add_u32 s3, s53, 30720
  v_lshlrev_b32 v58, 3, v63
  s_min_u32 s56, s54, 111
  s_lshl_b32 s24, s56, 6
  s_add_u32 s24, s24, 20480
  s_add_u32 s25, s24, 7168
  s_add_u32 s60, s24, 30720
  s_add_u32 s61, s25, 30720
  buffer_load_dwordx4 v[64:67], v57, s[40:43], s53 offen offset:0
  buffer_load_dwordx4 v[68:71], v57, s[40:43], s53 offen offset:16
  buffer_load_dwordx4 v[72:75], v57, s[40:43], s3 offen offset:0
  buffer_load_dwordx4 v[76:79], v57, s[40:43], s3 offen offset:16
  buffer_load_dwordx2 v[136:137], v58, s[40:43], s24 offen
  buffer_load_dwordx2 v[138:139], v58, s[40:43], s25 offen
  buffer_load_dwordx2 v[140:141], v58, s[40:43], s60 offen
  buffer_load_dwordx2 v[142:143], v58, s[40:43], s61 offen
  buffer_load_dwordx4 a[160:163], v146, s[28:31], s51 offen offset:0 nt
  buffer_load_dwordx4 a[164:167], v146, s[28:31], s51 offen offset:128 nt
  buffer_load_dwordx4 a[168:171], v146, s[28:31], s51 offen offset:2048 nt
  buffer_load_dwordx4 a[172:175], v146, s[28:31], s51 offen offset:2176 nt
  s_xor_b32 s51, s52, 0x931000
  buffer_load_dwordx4 a[176:179], v146, s[28:31], s51 offen offset:0 nt
  buffer_load_dwordx4 a[180:183], v146, s[28:31], s51 offen offset:128 nt
  buffer_load_dwordx4 a[184:187], v146, s[28:31], s51 offen offset:2048 nt
  buffer_load_dwordx4 a[188:191], v146, s[28:31], s51 offen offset:2176 nt
  s_xor_b32 s51, s52, 0x4a4000
  buffer_load_dwordx4 a[192:195], v1, s[28:31], s51 offen offset:0 nt
  buffer_load_dwordx4 a[196:199], v1, s[28:31], s51 offen offset:64 nt
  buffer_load_dwordx4 a[200:203], v1, s[28:31], s51 offen offset:128 nt
  buffer_load_dwordx4 a[204:207], v1, s[28:31], s51 offen offset:192 nt
  s_xor_b32 s51, s52, 0x5a5000
  buffer_load_dwordx4 a[208:211], v146, s[28:31], s51 offen offset:0 nt
  buffer_load_dwordx4 a[212:215], v146, s[28:31], s51 offen offset:128 nt
  buffer_load_dwordx4 a[216:219], v146, s[28:31], s51 offen offset:2048 nt
  buffer_load_dwordx4 a[220:223], v146, s[28:31], s51 offen offset:2176 nt
  s_xor_b32 s51, s52, 0xcb4000
  buffer_load_dwordx4 a[224:227], v1, s[28:31], s51 offen offset:0 nt
  buffer_load_dwordx4 a[228:231], v1, s[28:31], s51 offen offset:64 nt
  buffer_load_dwordx4 a[232:235], v1, s[28:31], s51 offen offset:128 nt
  buffer_load_dwordx4 a[236:239], v1, s[28:31], s51 offen offset:192 nt
  s_xor_b32 s51, s52, 0xdb5000
  buffer_load_dwordx4 a[240:243], v146, s[28:31], s51 offen offset:0 nt
  buffer_load_dwordx4 a[244:247], v146, s[28:31], s51 offen offset:128 nt
  buffer_load_dwordx4 a[248:251], v146, s[28:31], s51 offen offset:2048 nt
  buffer_load_dwordx4 a[252:255], v146, s[28:31], s51 offen offset:2176 nt
  s_xor_b32 s51, s52, 0x50000
  v_and_b32 v7, 8, v0
  v_lshlrev_b32 v7, 1, v7
  v_lshrrev_b32 v7, v7, s55
  v_and_b32 v189, 15, v7
  v_bfe_u32 v190, v7, 8, 4
  s_lshl_b32 s56, s48, 10
  v_add_u32 v147, s56, v2
  s_waitcnt vmcnt(24)
L_qchk:
  v_xor_b32 v64, s8, v64
  v_xor_b32 v65, s9, v65
  v_xor_b32 v66, s71, v66
  v_xor_b32 v67, s79, v67
  v_xor_b32 v68, s8, v68
  v_xor_b32 v69, s9, v69
  v_xor_b32 v70, s71, v70
  v_xor_b32 v71, s79, v71
  v_xor_b32 v72, s8, v72
  v_xor_b32 v73, s9, v73
  v_xor_b32 v74, s71, v74
  v_xor_b32 v75, s79, v75
  v_xor_b32 v76, s8, v76
  v_xor_b32 v77, s9, v77
  v_xor_b32 v78, s71, v78
  v_xor_b32 v79, s79, v79
  v_xor_b32 v136, v189, v136
  v_xor_b32 v137, v190, v137
  v_xor_b32 v138, v189, v138
  v_xor_b32 v139, v190, v139
  v_xor_b32 v140, v189, v140
  v_xor_b32 v141, v190, v141
  v_xor_b32 v142, v189, v142
  v_xor_b32 v143, v190, v143
  v_or_b32 v7, v64, v65
  v_or3_b32 v7, v7, v66, v67
  v_or3_b32 v7, v7, v68, v69
  v_or3_b32 v7, v7, v70, v71
  v_or3_b32 v7, v7, v72, v73
  v_or3_b32 v7, v7, v74, v75
  v_or3_b32 v7, v7, v76, v77
  v_or3_b32 v7, v7, v78, v79
  v_or3_b32 v7, v7, v136, v137
  v_or3_b32 v7, v7, v138, v139
  v_or3_b32 v7, v7, v140, v141
  v_or3_b32 v7, v7, v142, v143
  v_and_b32 v7, 15, v7
  v_cmp_ne_u32 vcc, 0, v7
  s_cbranch_vccnz L_qretry
L_qok:
  v_pk_add_f32 v[64:65], v[64:65], v[72:73]
  v_pk_add_f32 v[66:67], v[66:67], v[74:75]
  v_pk_add_f32 v[68:69], v[68:69], v[76:77]
  v_pk_add_f32 v[70:71], v[70:71], v[78:79]
  v_cvt_pk_bf16_f32 v64, v64, v65
  v_cvt_pk_bf16_f32 v65, v66, v67
  v_cvt_pk_bf16_f32 v66, v68, v69
  v_cvt_pk_bf16_f32 v67, v70, v71
  ds_write_b128 v147, v[64:67] offset:14848
  v_pk_add_f32 v[136:137], v[136:137], v[140:141]
  v_pk_add_f32 v[138:139], v[138:139], v[142:143]
  v_cvt_pk_bf16_f32 v136, v136, v136
  v_cvt_pk_bf16_f32 v137, v137, v137
  v_cvt_pk_bf16_f32 v138, v138, v138
  v_cvt_pk_bf16_f32 v139, v139, v139
  s_waitcnt lgkmcnt(0)
  s_barrier
  ds_read_b128 v[32:35], v2 offset:14848
  ds_read_b128 v[36:39], v2 offset:15872
  ds_read_b128 v[40:43], v2 offset:16896
  ds_read_b128 v[44:47], v2 offset:17920
  s_waitcnt lgkmcnt(0)
  v_cndmask_b32 v148, v32, v36, s[6:7]
  v_cndmask_b32 v149, v33, v37, s[6:7]
  v_cndmask_b32 v150, v34, v38, s[6:7]
  v_cndmask_b32 v151, v35, v39, s[6:7]
  v_cndmask_b32 v152, v40, v44, s[6:7]
  v_cndmask_b32 v153, v41, v45, s[6:7]
  v_cndmask_b32 v154, v42, v46, s[6:7]
  v_cndmask_b32 v155, v43, v47, s[6:7]
  v_mfma_f32_16x16x32_bf16 v[16:19], a[0:3], v[148:151], 0
  v_mfma_f32_16x16x32_bf16 v[20:23], a[8:11], v[148:151], 0
  v_mfma_f32_16x16x32_bf16 v[16:19], a[4:7], v[152:155], v[16:19]
  v_mfma_f32_16x16x32_bf16 v[20:23], a[12:15], v[152:155], v[20:23]
  buffer_load_dwordx4 a[0:3], v1, s[28:31], s51 offen offset:0 nt
  buffer_load_dwordx4 a[4:7], v1, s[28:31], s51 offen offset:64 nt
  buffer_load_dwordx4 a[8:11], v1, s[28:31], s51 offen offset:128 nt
  buffer_load_dwordx4 a[12:15], v1, s[28:31], s51 offen offset:192 nt
  s_xor_b32 s51, s52, 0x151000
  s_nop 1
  v_cndmask_b32 v7, v18, v17, s[16:17]
  v_cndmask_b32 v7, v7, v22, s[18:19]
  v_cndmask_b32 v7, v7, v21, s[10:11]
  v_cndmask_b32 v156, v16, v19, s[16:17]
  v_cndmask_b32 v156, v156, v20, s[18:19]
  v_cndmask_b32 v156, v156, v23, s[10:11]
  s_nop 1
  v_add_f32_dpp v156, v7, v156 quad_perm:[1,0,3,2] row_mask:0xf bank_mask:0xf
  v_cvt_pk_bf16_f32 v156, v156, v156
  v_and_b32 v156, s68, v156
  v_mul_f32 v156, s62, v156
  v_cvt_pk_bf16_f32 v156, v156, v156
  v_and_b32 v156, s68, v156
  v_mfma_f32_16x16x32_bf16 v[16:19], a[16:19], v[148:151], 0
  v_mfma_f32_16x16x32_bf16 v[20:23], a[24:27], v[148:151], 0
  v_mfma_f32_16x16x32_bf16 v[16:19], a[20:23], v[152:155], v[16:19]
  v_mfma_f32_16x16x32_bf16 v[20:23], a[28:31], v[152:155], v[20:23]
  s_nop 6
  v_cndmask_b32 v7, v18, v17, s[16:17]
  v_cndmask_b32 v7, v7, v22, s[18:19]
  v_cndmask_b32 v7, v7, v21, s[10:11]
  v_cndmask_b32 v157, v16, v19, s[16:17]
  v_cndmask_b32 v157, v157, v20, s[18:19]
  v_cndmask_b32 v157, v157, v23, s[10:11]
  s_nop 1
  v_add_f32_dpp v157, v7, v157 quad_perm:[1,0,3,2] row_mask:0xf bank_mask:0xf
  v_cvt_pk_bf16_f32 v157, v157, v157
  v_and_b32 v157, s68, v157
  v_mul_f32 v157, s62, v157
  v_cvt_pk_bf16_f32 v157, v157, v157
  v_and_b32 v157, s68, v157
  v_max_f32 v5, v156, v157
  s_cmp_lg_u32 s48, 1
  s_cbranch_scc1 L_noxg
  s_lshl_b32 s56, s49, 9
  s_add_u32 s56, s56, 196608
  v_lshlrev_b32 v7, 2, v0
  v_min_u32 v63, 3, v49
  v_lshlrev_b32 v63, 7, v63
  v_cmp_gt_u32 vcc, 32, v0
  s_nop 1
  v_cndmask_b32 v7, v63, v7, vcc
  buffer_load_dword v147, v7, s[40:43], s56 offen sc1
L_noxg:
  v_mfma_f32_16x16x32_bf16 v[16:19], a[32:35], v[148:151], 0
  v_mfma_f32_16x16x32_bf16 v[20:23], a[40:43], v[148:151], 0
  v_mfma_f32_16x16x32_bf16 v[16:19], a[36:39], v[152:155], v[16:19]
  v_mfma_f32_16x16x32_bf16 v[20:23], a[44:47], v[152:155], v[20:23]
  s_nop 6
  v_cndmask_b32 v7, v18, v17, s[16:17]
  v_cndmask_b32 v7, v7, v22, s[18:19]
  v_cndmask_b32 v7, v7, v21, s[10:11]
  v_cndmask_b32 v158, v16, v19, s[16:17]
  v_cndmask_b32 v158, v158, v20, s[18:19]
  v_cndmask_b32 v158, v158, v23, s[10:11]
  s_nop 1
  v_add_f32_dpp v158, v7, v158 quad_perm:[1,0,3,2] row_mask:0xf bank_mask:0xf
  v_cvt_pk_bf16_f32 v158, v158, v158
  v_and_b32 v158, s68, v158
  v_mul_f32 v158, s62, v158
  v_cvt_pk_bf16_f32 v158, v158, v158
  v_and_b32 v158, s68, v158
  v_mfma_f32_16x16x32_bf16 v[16:19], a[48:51], v[148:151], 0
  v_mfma_f32_16x16x32_bf16 v[20:23], a[56:59], v[148:151], 0
  v_mfma_f32_16x16x32_bf16 v[16:19], a[52:55], v[152:155], v[16:19]
  v_mfma_f32_16x16x32_bf16 v[20:23], a[60:63], v[152:155], v[20:23]
  buffer_load_dwordx4 a[16:19], v146, s[28:31], s51 offen offset:0 nt
  buffer_load_dwordx4 a[20:23], v146, s[28:31], s51 offen offset:128 nt
  buffer_load_dwordx4 a[24:27], v146, s[28:31], s51 offen offset:2048 nt
  buffer_load_dwordx4 a[28:31], v146, s[28:31], s51 offen offset:2176 nt
  s_xor_b32 s51, s52, 0x840000
  s_nop 1
  v_cndmask_b32 v7, v18, v17, s[16:17]
  v_cndmask_b32 v7, v7, v22, s[18:19]
  v_cndmask_b32 v7, v7, v21, s[10:11]
  v_cndmask_b32 v159, v16, v19, s[16:17]
  v_cndmask_b32 v159, v159, v20, s[18:19]
  v_cndmask_b32 v159, v159, v23, s[10:11]
  s_nop 1
  v_add_f32_dpp v159, v7, v159 quad_perm:[1,0,3,2] row_mask:0xf bank_mask:0xf
  v_cvt_pk_bf16_f32 v159, v159, v159
  v_and_b32 v159, s68, v159
  v_mul_f32 v159, s62, v159
  v_cvt_pk_bf16_f32 v159, v159, v159
  v_and_b32 v159, s68, v159
  v_max3_f32 v5, v5, v158, v159
  v_mfma_f32_16x16x32_bf16 v[16:19], a[64:67], v[148:151], 0
  v_mfma_f32_16x16x32_bf16 v[20:23], a[72:75], v[148:151], 0
  v_mfma_f32_16x16x32_bf16 v[16:19], a[68:71], v[152:155], v[16:19]
  v_mfma_f32_16x16x32_bf16 v[20:23], a[76:79], v[152:155], v[20:23]
  s_nop 6
  v_cndmask_b32 v7, v18, v17, s[16:17]
  v_cndmask_b32 v7, v7, v22, s[18:19]
  v_cndmask_b32 v7, v7, v21, s[10:11]
  v_cndmask_b32 v160, v16, v19, s[16:17]
  v_cndmask_b32 v160, v160, v20, s[18:19]
  v_cndmask_b32 v160, v160, v23, s[10:11]
  s_nop 1
  v_add_f32_dpp v160, v7, v160 quad_perm:[1,0,3,2] row_mask:0xf bank_mask:0xf
  v_cvt_pk_bf16_f32 v160, v160, v160
  v_and_b32 v160, s68, v160
  v_mul_f32 v160, s62, v160
  v_cvt_pk_bf16_f32 v160, v160, v160
  v_and_b32 v160, s68, v160
  v_mfma_f32_16x16x32_bf16 v[16:19], a[80:83], v[148:151], 0
  v_mfma_f32_16x16x32_bf16 v[20:23], a[88:91], v[148:151], 0
  v_mfma_f32_16x16x32_bf16 v[16:19], a[84:87], v[152:155], v[16:19]
  v_mfma_f32_16x16x32_bf16 v[20:23], a[92:95], v[152:155], v[20:23]
  s_nop 6
  v_cndmask_b32 v7, v18, v17, s[16:17]
  v_cndmask_b32 v7, v7, v22, s[18:19]
  v_cndmask_b32 v7, v7, v21, s[10:11]
  v_cndmask_b32 v161, v16, v19, s[16:17]
  v_cndmask_b32 v161, v161, v20, s[18:19]
  v_cndmask_b32 v161, v161, v23, s[10:11]
  s_nop 1
  v_add_f32_dpp v161, v7, v161 quad_perm:[1,0,3,2] row_mask:0xf bank_mask:0xf
  v_cvt_pk_bf16_f32 v161, v161, v161
  v_and_b32 v161, s68, v161
  v_mul_f32 v161, s62, v161
  v_cvt_pk_bf16_f32 v161, v161, v161
  v_and_b32 v161, s68, v161
  v_max3_f32 v5, v5, v160, v161
  v_and_b32 v136, s68, v136
  v_and_b32 v137, s68, v137
  v_and_b32 v138, s68, v138
  v_and_b32 v139, s68, v139
  v_mul_f32 v136, 0xbfb8aa3b, v136
  v_mul_f32 v137, 0xbfb8aa3b, v137
  v_exp_f32 v136, v136
  v_exp_f32 v137, v137
  v_add_f32 v136, 1.0, v136
  v_add_f32 v137, 1.0, v137
  v_rcp_f32 v136, v136
  v_rcp_f32 v137, v137
  v_cvt_pk_bf16_f32 v136, v136, v136
  v_cvt_pk_bf16_f32 v137, v137, v137
  v_and_b32 v136, s68, v136
  v_and_b32 v137, s68, v137
  v_mul_f32 v136, v136, v138
  v_mul_f32 v137, v137, v139
  v_cvt_pk_bf16_f32 v136, v136, v136
  v_cvt_pk_bf16_f32 v137, v137, v137
  v_and_b32 v24, v136, v124
  v_and_b32 v25, v136, v125
  v_and_b32 v26, v136, v126
  v_and_b32 v27, v136, v127
  v_and_b32 v28, v137, v124
  v_and_b32 v29, v137, v125
  v_and_b32 v30, v137, v126
  v_and_b32 v31, v137, v127
  v_mfma_f32_16x16x32_bf16 v[8:11], v[24:27], v[96:99], 0
  s_nop 0
  v_mfma_f32_16x16x32_bf16 v[8:11], v[28:31], v[100:103], v[8:11]
  v_lshrrev_b32 v57, 2, v0
  v_lshlrev_b32 v57, 11, v57
  v_lshl_add_u32 v57, v49, 4, v57
  v_lshlrev_b32 v58, 4, v50
  v_lshl_add_u32 v58, v49, 6, v58
  v_lshl_add_u32 v58, v48, 8, v58
  s_and_b32 s56, s50, 28
  s_add_u32 s60, s56, s48
  s_lshl_b32 s56, s49, 16
  s_lshl_b32 s57, s60, 6
  s_add_u32 s24, s56, s57
  s_add_u32 s24, s24, 524288
  s_add_u32 s25, s24, 0x8000
  s_lshl_b32 s3, s49, 11
  s_add_u32 s3, s3, 131072
  s_lshl_b32 s56, s49, 19
  s_lshl_b32 s57, s60, 12
  s_add_u32 s53, s56, s57
  s_and_b32 s56, s50, 3
  s_lshl_b32 s56, s56, 8
  s_add_u32 s53, s53, s56
  s_mov_b64 s[44:45], s[12:13]
  s_mov_b32 s46, 4194304
  s_mov_b32 exec_lo, 0x00ff00ff
  s_mov_b32 exec_hi, 0xff00ff00
  ds_write_b128 v62, v[8:11] offset:2048
  s_mov_b64 exec, -1
  v_mfma_f32_16x16x32_bf16 v[16:19], a[96:99], v[148:151], 0
  v_mfma_f32_16x16x32_bf16 v[20:23], a[104:107], v[148:151], 0
  v_mfma_f32_16x16x32_bf16 v[16:19], a[100:103], v[152:155], v[16:19]
  v_mfma_f32_16x16x32_bf16 v[20:23], a[108:111], v[152:155], v[20:23]
  s_lshl_b32 s56, s49, 9
  s_add_u32 s56, s56, 196736
  s_cmp_lg_u32 s48, 1
  s_cbranch_scc1 L_noflag0
  s_lshl_b32 s57, s50, 2
  s_add_u32 s57, s57, s56
  v_mov_b32 v134, s55
  s_mov_b64 exec, 1
  buffer_store_dword v134, v2, s[40:43], s57 offen
  s_mov_b64 exec, -1
L_noflag0:
  v_and_b32 v135, 31, v0
  v_lshlrev_b32 v135, 2, v135
  buffer_load_dword v104, v135, s[40:43], s56 offen sc1
  buffer_load_dwordx4 a[32:35], v146, s[28:31], s51 offen offset:0 nt
  buffer_load_dwordx4 a[36:39], v146, s[28:31], s51 offen offset:128 nt
  buffer_load_dwordx4 a[40:43], v146, s[28:31], s51 offen offset:2048 nt
  buffer_load_dwordx4 a[44:47], v146, s[28:31], s51 offen offset:2176 nt
  s_xor_b32 s51, s52, 0x941000
  v_cndmask_b32 v7, v18, v17, s[16:17]
  v_cndmask_b32 v7, v7, v22, s[18:19]
  v_cndmask_b32 v7, v7, v21, s[10:11]
  v_cndmask_b32 v162, v16, v19, s[16:17]
  v_cndmask_b32 v162, v162, v20, s[18:19]
  v_cndmask_b32 v162, v162, v23, s[10:11]
  s_nop 1
  v_add_f32_dpp v162, v7, v162 quad_perm:[1,0,3,2] row_mask:0xf bank_mask:0xf
  v_cvt_pk_bf16_f32 v162, v162, v162
  v_and_b32 v162, s68, v162
  v_mul_f32 v162, s62, v162
  v_cvt_pk_bf16_f32 v162, v162, v162
  v_and_b32 v162, s68, v162
  v_mfma_f32_16x16x32_bf16 v[16:19], a[112:115], v[148:151], 0
  v_mfma_f32_16x16x32_bf16 v[20:23], a[120:123], v[148:151], 0
  v_mfma_f32_16x16x32_bf16 v[16:19], a[116:119], v[152:155], v[16:19]
  v_mfma_f32_16x16x32_bf16 v[20:23], a[124:127], v[152:155], v[20:23]
  s_nop 6
  v_cndmask_b32 v7, v18, v17, s[16:17]
  v_cndmask_b32 v7, v7, v22, s[18:19]
  v_cndmask_b32 v7, v7, v21, s[10:11]
  v_cndmask_b32 v163, v16, v19, s[16:17]
  v_cndmask_b32 v163, v163, v20, s[18:19]
  v_cndmask_b32 v163, v163, v23, s[10:11]
  s_nop 1
  v_add_f32_dpp v163, v7, v163 quad_perm:[1,0,3,2] row_mask:0xf bank_mask:0xf
  v_cvt_pk_bf16_f32 v163, v163, v163
  v_and_b32 v163, s68, v163
  v_mul_f32 v163, s62, v163
  v_cvt_pk_bf16_f32 v163, v163, v163
  v_and_b32 v163, s68, v163
  v_max3_f32 v5, v5, v162, v163
  v_mfma_f32_16x16x32_bf16 v[16:19], a[128:131], v[32:35], 0
  v_mfma_f32_16x16x32_bf16 v[16:19], a[132:135], v[36:39], v[16:19]
  v_mfma_f32_16x16x32_bf16 v[16:19], a[136:139], v[40:43], v[16:19]
  v_mfma_f32_16x16x32_bf16 v[16:19], a[140:143], v[44:47], v[16:19]
  s_nop 7
  v_cndmask_b32 v164, v16, v17, s[16:17]
  v_cndmask_b32 v164, v164, v18, s[18:19]
  v_cndmask_b32 v164, v164, v19, s[10:11]
  v_cvt_pk_bf16_f32 v164, v164, v164
  v_and_b32 v164, s68, v164
  v_mul_f32 v164, s62, v164
  v_cvt_pk_bf16_f32 v164, v164, v164
  v_and_b32 v164, s68, v164
  v_mfma_f32_16x16x32_bf16 v[16:19], a[144:147], v[148:151], 0
  v_mfma_f32_16x16x32_bf16 v[20:23], a[152:155], v[148:151], 0
  v_mfma_f32_16x16x32_bf16 v[16:19], a[148:151], v[152:155], v[16:19]
  v_mfma_f32_16x16x32_bf16 v[20:23], a[156:159], v[152:155], v[20:23]
  buffer_load_dwordx4 a[48:51], v146, s[28:31], s51 offen offset:0 nt
  buffer_load_dwordx4 a[52:55], v146, s[28:31], s51 offen offset:128 nt
  buffer_load_dwordx4 a[56:59], v146, s[28:31], s51 offen offset:2048 nt
  buffer_load_dwordx4 a[60:63], v146, s[28:31], s51 offen offset:2176 nt
  s_xor_b32 s51, s52, 0x4d4000
  s_nop 1
  v_cndmask_b32 v7, v18, v17, s[16:17]
  v_cndmask_b32 v7, v7, v22, s[18:19]
  v_cndmask_b32 v7, v7, v21, s[10:11]
  v_cndmask_b32 v165, v16, v19, s[16:17]
  v_cndmask_b32 v165, v165, v20, s[18:19]
  v_cndmask_b32 v165, v165, v23, s[10:11]
  s_nop 1
  v_add_f32_dpp v165, v7, v165 quad_perm:[1,0,3,2] row_mask:0xf bank_mask:0xf
  v_cvt_pk_bf16_f32 v165, v165, v165
  v_and_b32 v165, s68, v165
  v_mul_f32 v165, s62, v165
  v_cvt_pk_bf16_f32 v165, v165, v165
  v_and_b32 v165, s68, v165
  v_max3_f32 v5, v5, v164, v165
  s_waitcnt vmcnt(37)
  v_mfma_f32_16x16x32_bf16 v[16:19], a[160:163], v[148:151], 0
  v_mfma_f32_16x16x32_bf16 v[20:23], a[168:171], v[148:151], 0
  v_mfma_f32_16x16x32_bf16 v[16:19], a[164:167], v[152:155], v[16:19]
  v_mfma_f32_16x16x32_bf16 v[20:23], a[172:175], v[152:155], v[20:23]
  s_nop 6
  v_cndmask_b32 v7, v18, v17, s[16:17]
  v_cndmask_b32 v7, v7, v22, s[18:19]
  v_cndmask_b32 v7, v7, v21, s[10:11]
  v_cndmask_b32 v166, v16, v19, s[16:17]
  v_cndmask_b32 v166, v166, v20, s[18:19]
  v_cndmask_b32 v166, v166, v23, s[10:11]
  s_nop 1
  v_add_f32_dpp v166, v7, v166 quad_perm:[1,0,3,2] row_mask:0xf bank_mask:0xf
  v_cvt_pk_bf16_f32 v166, v166, v166
  v_and_b32 v166, s68, v166
  v_mul_f32 v166, s62, v166
  v_cvt_pk_bf16_f32 v166, v166, v166
  v_and_b32 v166, s68, v166
  s_waitcnt vmcnt(33)
  v_mfma_f32_16x16x32_bf16 v[16:19], a[176:179], v[148:151], 0
  v_mfma_f32_16x16x32_bf16 v[20:23], a[184:187], v[148:151], 0
  v_mfma_f32_16x16x32_bf16 v[16:19], a[180:183], v[152:155], v[16:19]
  v_mfma_f32_16x16x32_bf16 v[20:23], a[188:191], v[152:155], v[20:23]
  s_nop 6
  v_cndmask_b32 v7, v18, v17, s[16:17]
  v_cndmask_b32 v7, v7, v22, s[18:19]
  v_cndmask_b32 v7, v7, v21, s[10:11]
  v_cndmask_b32 v167, v16, v19, s[16:17]
  v_cndmask_b32 v167, v167, v20, s[18:19]
  v_cndmask_b32 v167, v167, v23, s[10:11]
  s_nop 1
  v_add_f32_dpp v167, v7, v167 quad_perm:[1,0,3,2] row_mask:0xf bank_mask:0xf
  v_cvt_pk_bf16_f32 v167, v167, v167
  v_and_b32 v167, s68, v167
  v_mul_f32 v167, s62, v167
  v_cvt_pk_bf16_f32 v167, v167, v167
  v_and_b32 v167, s68, v167
  v_max3_f32 v5, v5, v166, v167
  s_waitcnt vmcnt(29)
  v_mfma_f32_16x16x32_bf16 v[16:19], a[192:195], v[32:35], 0
  v_mfma_f32_16x16x32_bf16 v[16:19], a[196:199], v[36:39], v[16:19]
  v_mfma_f32_16x16x32_bf16 v[16:19], a[200:203], v[40:43], v[16:19]
  v_mfma_f32_16x16x32_bf16 v[16:19], a[204:207], v[44:47], v[16:19]
  buffer_load_dwordx4 a[64:67], v1, s[28:31], s51 offen offset:0 nt
  buffer_load_dwordx4 a[68:71], v1, s[28:31], s51 offen offset:64 nt
  buffer_load_dwordx4 a[72:75], v1, s[28:31], s51 offen offset:128 nt
  buffer_load_dwordx4 a[76:79], v1, s[28:31], s51 offen offset:192 nt
  s_xor_b32 s51, s52, 0x5d5000
  s_nop 2
  v_cndmask_b32 v168, v16, v17, s[16:17]
  v_cndmask_b32 v168, v168, v18, s[18:19]
  v_cndmask_b32 v168, v168, v19, s[10:11]
  v_cvt_pk_bf16_f32 v168, v168, v168
  v_and_b32 v168, s68, v168
  v_mul_f32 v168, s62, v168
  v_cvt_pk_bf16_f32 v168, v168, v168
  v_and_b32 v168, s68, v168
  s_waitcnt vmcnt(29)
  v_mfma_f32_16x16x32_bf16 v[16:19], a[208:211], v[148:151], 0
  v_mfma_f32_16x16x32_bf16 v[20:23], a[216:219], v[148:151], 0
  v_mfma_f32_16x16x32_bf16 v[16:19], a[212:215], v[152:155], v[16:19]
  v_mfma_f32_16x16x32_bf16 v[20:23], a[220:223], v[152:155], v[20:23]
  s_nop 6
  v_cndmask_b32 v7, v18, v17, s[16:17]
  v_cndmask_b32 v7, v7, v22, s[18:19]
  v_cndmask_b32 v7, v7, v21, s[10:11]
  v_cndmask_b32 v169, v16, v19, s[16:17]
  v_cndmask_b32 v169, v169, v20, s[18:19]
  v_cndmask_b32 v169, v169, v23, s[10:11]
  s_nop 1
  v_add_f32_dpp v169, v7, v169 quad_perm:[1,0,3,2] row_mask:0xf bank_mask:0xf
  v_cvt_pk_bf16_f32 v169, v169, v169
  v_and_b32 v169, s68, v169
  v_mul_f32 v169, s62, v169
  v_cvt_pk_bf16_f32 v169, v169, v169
  v_and_b32 v169, s68, v169
  v_max3_f32 v5, v5, v168, v169
  s_waitcnt vmcnt(25)
  v_mfma_f32_16x16x32_bf16 v[16:19], a[224:227], v[32:35], 0
  v_mfma_f32_16x16x32_bf16 v[16:19], a[228:231], v[36:39], v[16:19]
  v_mfma_f32_16x16x32_bf16 v[16:19], a[232:235], v[40:43], v[16:19]
  v_mfma_f32_16x16x32_bf16 v[16:19], a[236:239], v[44:47], v[16:19]
  s_nop 7
  v_cndmask_b32 v170, v16, v17, s[16:17]
  v_cndmask_b32 v170, v170, v18, s[18:19]
  v_cndmask_b32 v170, v170, v19, s[10:11]
  v_cvt_pk_bf16_f32 v170, v170, v170
  v_and_b32 v170, s68, v170
  v_mul_f32 v170, s62, v170
  v_cvt_pk_bf16_f32 v170, v170, v170
  v_and_b32 v170, s68, v170
  s_waitcnt vmcnt(21)
  v_mfma_f32_16x16x32_bf16 v[16:19], a[240:243], v[148:151], 0
  v_mfma_f32_16x16x32_bf16 v[20:23], a[248:251], v[148:151], 0
  v_mfma_f32_16x16x32_bf16 v[16:19], a[244:247], v[152:155], v[16:19]
  v_mfma_f32_16x16x32_bf16 v[20:23], a[252:255], v[152:155], v[20:23]
  buffer_load_dwordx4 a[80:83], v146, s[28:31], s51 offen offset:0 nt
  buffer_load_dwordx4 a[84:87], v146, s[28:31], s51 offen offset:128 nt
  buffer_load_dwordx4 a[88:91], v146, s[28:31], s51 offen offset:2048 nt
  buffer_load_dwordx4 a[92:95], v146, s[28:31], s51 offen offset:2176 nt
  s_xor_b32 s51, s52, 0xcc4000
  s_nop 1
  v_cndmask_b32 v7, v18, v17, s[16:17]
  v_cndmask_b32 v7, v7, v22, s[18:19]
  v_cndmask_b32 v7, v7, v21, s[10:11]
  v_cndmask_b32 v171, v16, v19, s[16:17]
  v_cndmask_b32 v171, v171, v20, s[18:19]
  v_cndmask_b32 v171, v171, v23, s[10:11]
  s_nop 1
  v_add_f32_dpp v171, v7, v171 quad_perm:[1,0,3,2] row_mask:0xf bank_mask:0xf
  v_cvt_pk_bf16_f32 v171, v171, v171
  v_and_b32 v171, s68, v171
  v_mul_f32 v171, s62, v171
  v_cvt_pk_bf16_f32 v171, v171, v171
  v_and_b32 v171, s68, v171
  v_max3_f32 v5, v5, v170, v171
  s_waitcnt vmcnt(21)
  v_mfma_f32_16x16x32_bf16 v[16:19], a[0:3], v[32:35], 0
  v_mfma_f32_16x16x32_bf16 v[16:19], a[4:7], v[36:39], v[16:19]
  v_mfma_f32_16x16x32_bf16 v[16:19], a[8:11], v[40:43], v[16:19]
  v_mfma_f32_16x16x32_bf16 v[16:19], a[12:15], v[44:47], v[16:19]
  s_nop 7
  v_cndmask_b32 v172, v16, v17, s[16:17]
  v_cndmask_b32 v172, v172, v18, s[18:19]
  v_cndmask_b32 v172, v172, v19, s[10:11]
  v_cvt_pk_bf16_f32 v172, v172, v172
  v_and_b32 v172, s68, v172
  v_mul_f32 v172, s62, v172
  v_cvt_pk_bf16_f32 v172, v172, v172
  v_and_b32 v172, s68, v172
  s_waitcnt vmcnt(17)
  v_mfma_f32_16x16x32_bf16 v[16:19], a[16:19], v[148:151], 0
  v_mfma_f32_16x16x32_bf16 v[20:23], a[24:27], v[148:151], 0
  v_mfma_f32_16x16x32_bf16 v[16:19], a[20:23], v[152:155], v[16:19]
  v_mfma_f32_16x16x32_bf16 v[20:23], a[28:31], v[152:155], v[20:23]
  s_waitcnt vmcnt(16)
  v_cmp_eq_u32 vcc, s55, v104
  s_bcnt1_i32_b32 s56, vcc_lo
  s_mov_b32 s14, 0
  s_cmp_gt_u32 s56, 19
  s_addc_u32 s14, s14, 0
  s_cmp_gt_u32 s56, 22
  s_addc_u32 s14, s14, 0
  s_cmp_gt_u32 s56, 24
  s_addc_u32 s14, s14, 0
  s_cmp_gt_u32 s56, 28
  s_addc_u32 s14, s14, 0
  s_cmp_gt_u32 s56, 30
  s_addc_u32 s14, s14, 0
  s_cmp_le_i32 s14, 4
  s_cbranch_scc1 L_vs22
  buffer_load_dwordx4 a[96:99], v146, s[28:31], s51 offen offset:0 nt
  buffer_load_dwordx4 a[100:103], v146, s[28:31], s51 offen offset:128 nt
  buffer_load_dwordx4 a[104:107], v146, s[28:31], s51 offen offset:2048 nt
  buffer_load_dwordx4 a[108:111], v146, s[28:31], s51 offen offset:2176 nt
L_vj22:
  s_xor_b32 s51, s52, 0xdc5000
  v_cndmask_b32 v7, v18, v17, s[16:17]
  v_cndmask_b32 v7, v7, v22, s[18:19]
  v_cndmask_b32 v7, v7, v21, s[10:11]
  v_cndmask_b32 v173, v16, v19, s[16:17]
  v_cndmask_b32 v173, v173, v20, s[18:19]
  v_cndmask_b32 v173, v173, v23, s[10:11]
  s_nop 1
  v_add_f32_dpp v173, v7, v173 quad_perm:[1,0,3,2] row_mask:0xf bank_mask:0xf
  v_cvt_pk_bf16_f32 v173, v173, v173
  v_and_b32 v173, s68, v173
  v_mul_f32 v173, s62, v173
  v_cvt_pk_bf16_f32 v173, v173, v173
  v_and_b32 v173, s68, v173
  v_max3_f32 v5, v5, v172, v173
  s_cmp_lg_u32 s48, 1
  s_cbranch_scc1 L_noxg2
  v_cmp_ne_u32 vcc, s59, v147
  s_cmp_eq_u32 vcc_lo, 0
  s_cselect_b32 s56, 1, 0
  v_mov_b32 v7, 0
  v_mov_b32 v63, s56
  ds_write_b32 v7, v63 offset:4096
L_noxg2:
  s_waitcnt vmcnt(16)
  v_mfma_f32_16x16x32_bf16 v[16:19], a[32:35], v[148:151], 0
  v_mfma_f32_16x16x32_bf16 v[20:23], a[40:43], v[148:151], 0
  v_mfma_f32_16x16x32_bf16 v[16:19], a[36:39], v[152:155], v[16:19]
  v_mfma_f32_16x16x32_bf16 v[20:23], a[44:47], v[152:155], v[20:23]
  buffer_load_dwordx4 a[112:115], v146, s[28:31], s51 offen offset:0 nt
  buffer_load_dwordx4 a[116:119], v146, s[28:31], s51 offen offset:128 nt
  buffer_load_dwordx4 a[120:123], v146, s[28:31], s51 offen offset:2048 nt
  buffer_load_dwordx4 a[124:127], v146, s[28:31], s51 offen offset:2176 nt
  s_xor_b32 s51, s52, 0x70000
  s_nop 1
  v_cndmask_b32 v7, v18, v17, s[16:17]
  v_cndmask_b32 v7, v7, v22, s[18:19]
  v_cndmask_b32 v7, v7, v21, s[10:11]
  v_cndmask_b32 v174, v16, v19, s[16:17]
  v_cndmask_b32 v174, v174, v20, s[18:19]
  v_cndmask_b32 v174, v174, v23, s[10:11]
  s_nop 1
  v_add_f32_dpp v174, v7, v174 quad_perm:[1,0,3,2] row_mask:0xf bank_mask:0xf
  v_cvt_pk_bf16_f32 v174, v174, v174
  v_and_b32 v174, s68, v174
  v_mul_f32 v174, s62, v174
  v_cvt_pk_bf16_f32 v174, v174, v174
  v_and_b32 v174, s68, v174
  s_waitcnt vmcnt(16)
  v_mfma_f32_16x16x32_bf16 v[16:19], a[48:51], v[148:151], 0
  v_mfma_f32_16x16x32_bf16 v[20:23], a[56:59], v[148:151], 0
  v_mfma_f32_16x16x32_bf16 v[16:19], a[52:55], v[152:155], v[16:19]
  v_mfma_f32_16x16x32_bf16 v[20:23], a[60:63], v[152:155], v[20:23]
  s_cmp_le_i32 s14, 0
  s_cbranch_scc1 L_vs24
  buffer_load_dwordx4 a[128:131], v146, s[28:31], s51 offen offset:0 nt
  buffer_load_dwordx4 a[132:135], v146, s[28:31], s51 offen offset:128 nt
  buffer_load_dwordx4 a[136:139], v146, s[28:31], s51 offen offset:2048 nt
  buffer_load_dwordx4 a[140:143], v146, s[28:31], s51 offen offset:2176 nt
L_vj24:
  s_xor_b32 s51, s52, 0x171000
  v_cndmask_b32 v7, v18, v17, s[16:17]
  v_cndmask_b32 v7, v7, v22, s[18:19]
  v_cndmask_b32 v7, v7, v21, s[10:11]
  v_cndmask_b32 v175, v16, v19, s[16:17]
  v_cndmask_b32 v175, v175, v20, s[18:19]
  v_cndmask_b32 v175, v175, v23, s[10:11]
  s_nop 1
  v_add_f32_dpp v175, v7, v175 quad_perm:[1,0,3,2] row_mask:0xf bank_mask:0xf
  v_cvt_pk_bf16_f32 v175, v175, v175
  v_and_b32 v175, s68, v175
  v_mul_f32 v175, s62, v175
  v_cvt_pk_bf16_f32 v175, v175, v175
  v_and_b32 v175, s68, v175
  v_max3_f32 v5, v5, v174, v175
  s_waitcnt vmcnt(16)
  v_mfma_f32_16x16x32_bf16 v[16:19], a[64:67], v[32:35], 0
  v_mfma_f32_16x16x32_bf16 v[16:19], a[68:71], v[36:39], v[16:19]
  v_mfma_f32_16x16x32_bf16 v[16:19], a[72:75], v[40:43], v[16:19]
  v_mfma_f32_16x16x32_bf16 v[16:19], a[76:79], v[44:47], v[16:19]
  buffer_load_dwordx4 a[144:147], v146, s[28:31], s51 offen offset:0 nt
  buffer_load_dwordx4 a[148:151], v146, s[28:31], s51 offen offset:128 nt
  buffer_load_dwordx4 a[152:155], v146, s[28:31], s51 offen offset:2048 nt
  buffer_load_dwordx4 a[156:159], v146, s[28:31], s51 offen offset:2176 nt
  s_xor_b32 s51, s52, 0x860000
  s_nop 2
  v_cndmask_b32 v176, v16, v17, s[16:17]
  v_cndmask_b32 v176, v176, v18, s[18:19]
  v_cndmask_b32 v176, v176, v19, s[10:11]
  v_cvt_pk_bf16_f32 v176, v176, v176
  v_and_b32 v176, s68, v176
  v_mul_f32 v176, s62, v176
  v_cvt_pk_bf16_f32 v176, v176, v176
  v_and_b32 v176, s68, v176
  s_waitcnt vmcnt(16)
  v_mfma_f32_16x16x32_bf16 v[16:19], a[80:83], v[148:151], 0
  v_mfma_f32_16x16x32_bf16 v[20:23], a[88:91], v[148:151], 0
  v_mfma_f32_16x16x32_bf16 v[16:19], a[84:87], v[152:155], v[16:19]
  v_mfma_f32_16x16x32_bf16 v[20:23], a[92:95], v[152:155], v[20:23]
  s_cmp_le_i32 s14, 3
  s_cbranch_scc1 L_vs26
  buffer_load_dwordx4 a[160:163], v146, s[28:31], s51 offen offset:0 nt
  buffer_load_dwordx4 a[164:167], v146, s[28:31], s51 offen offset:128 nt
  buffer_load_dwordx4 a[168:171], v146, s[28:31], s51 offen offset:2048 nt
  buffer_load_dwordx4 a[172:175], v146, s[28:31], s51 offen offset:2176 nt
L_vj26:
  s_xor_b32 s51, s52, 0x961000
  v_cndmask_b32 v7, v18, v17, s[16:17]
  v_cndmask_b32 v7, v7, v22, s[18:19]
  v_cndmask_b32 v7, v7, v21, s[10:11]
  v_cndmask_b32 v177, v16, v19, s[16:17]
  v_cndmask_b32 v177, v177, v20, s[18:19]
  v_cndmask_b32 v177, v177, v23, s[10:11]
  s_nop 1
  v_add_f32_dpp v177, v7, v177 quad_perm:[1,0,3,2] row_mask:0xf bank_mask:0xf
  v_cvt_pk_bf16_f32 v177, v177, v177
  v_and_b32 v177, s68, v177
  v_mul_f32 v177, s62, v177
  v_cvt_pk_bf16_f32 v177, v177, v177
  v_and_b32 v177, s68, v177
  v_max3_f32 v5, v5, v176, v177
  s_waitcnt vmcnt(16)
  v_mfma_f32_16x16x32_bf16 v[16:19], a[96:99], v[148:151], 0
  v_mfma_f32_16x16x32_bf16 v[20:23], a[104:107], v[148:151], 0
  v_mfma_f32_16x16x32_bf16 v[16:19], a[100:103], v[152:155], v[16:19]
  v_mfma_f32_16x16x32_bf16 v[20:23], a[108:111], v[152:155], v[20:23]
  buffer_load_dwordx4 a[176:179], v146, s[28:31], s51 offen offset:0 nt
  buffer_load_dwordx4 a[180:183], v146, s[28:31], s51 offen offset:128 nt
  buffer_load_dwordx4 a[184:187], v146, s[28:31], s51 offen offset:2048 nt
  buffer_load_dwordx4 a[188:191], v146, s[28:31], s51 offen offset:2176 nt
  s_xor_b32 s51, s52, 0x4f4000
  s_nop 1
  v_cndmask_b32 v7, v18, v17, s[16:17]
  v_cndmask_b32 v7, v7, v22, s[18:19]
  v_cndmask_b32 v7, v7, v21, s[10:11]
  v_cndmask_b32 v178, v16, v19, s[16:17]
  v_cndmask_b32 v178, v178, v20, s[18:19]
  v_cndmask_b32 v178, v178, v23, s[10:11]
  s_nop 1
  v_add_f32_dpp v178, v7, v178 quad_perm:[1,0,3,2] row_mask:0xf bank_mask:0xf
  v_cvt_pk_bf16_f32 v178, v178, v178
  v_and_b32 v178, s68, v178
  v_mul_f32 v178, s62, v178
  v_cvt_pk_bf16_f32 v178, v178, v178
  v_and_b32 v178, s68, v178
  s_waitcnt vmcnt(16)
  v_mfma_f32_16x16x32_bf16 v[16:19], a[112:115], v[148:151], 0
  v_mfma_f32_16x16x32_bf16 v[20:23], a[120:123], v[148:151], 0
  v_mfma_f32_16x16x32_bf16 v[16:19], a[116:119], v[152:155], v[16:19]
  v_mfma_f32_16x16x32_bf16 v[20:23], a[124:127], v[152:155], v[20:23]
  s_cmp_le_i32 s14, 1
  s_cbranch_scc1 L_vs28
  buffer_load_dwordx4 a[192:195], v146, s[28:31], s51 offen offset:0 nt
  buffer_load_dwordx4 a[196:199], v146, s[28:31], s51 offen offset:128 nt
  buffer_load_dwordx4 a[200:203], v146, s[28:31], s51 offen offset:2048 nt
  buffer_load_dwordx4 a[204:207], v146, s[28:31], s51 offen offset:2176 nt
L_vj28:
  s_xor_b32 s51, s52, 0x5f5000
  v_cndmask_b32 v7, v18, v17, s[16:17]
  v_cndmask_b32 v7, v7, v22, s[18:19]
  v_cndmask_b32 v7, v7, v21, s[10:11]
  v_cndmask_b32 v179, v16, v19, s[16:17]
  v_cndmask_b32 v179, v179, v20, s[18:19]
  v_cndmask_b32 v179, v179, v23, s[10:11]
  s_nop 1
  v_add_f32_dpp v179, v7, v179 quad_perm:[1,0,3,2] row_mask:0xf bank_mask:0xf
  v_cvt_pk_bf16_f32 v179, v179, v179
  v_and_b32 v179, s68, v179
  v_mul_f32 v179, s62, v179
  v_cvt_pk_bf16_f32 v179, v179, v179
  v_and_b32 v179, s68, v179
  v_max3_f32 v5, v5, v178, v179
  s_waitcnt vmcnt(16)
  v_mfma_f32_16x16x32_bf16 v[16:19], a[128:131], v[148:151], 0
  v_mfma_f32_16x16x32_bf16 v[20:23], a[136:139], v[148:151], 0
  v_mfma_f32_16x16x32_bf16 v[16:19], a[132:135], v[152:155], v[16:19]
  v_mfma_f32_16x16x32_bf16 v[20:23], a[140:143], v[152:155], v[20:23]
  buffer_load_dwordx4 a[208:211], v146, s[28:31], s51 offen offset:0 nt
  buffer_load_dwordx4 a[212:215], v146, s[28:31], s51 offen offset:128 nt
  buffer_load_dwordx4 a[216:219], v146, s[28:31], s51 offen offset:2048 nt
  buffer_load_dwordx4 a[220:223], v146, s[28:31], s51 offen offset:2176 nt
  s_xor_b32 s51, s52, 0xce4000
  s_nop 1
  v_cndmask_b32 v7, v18, v17, s[16:17]
  v_cndmask_b32 v7, v7, v22, s[18:19]
  v_cndmask_b32 v7, v7, v21, s[10:11]
  v_cndmask_b32 v180, v16, v19, s[16:17]
  v_cndmask_b32 v180, v180, v20, s[18:19]
  v_cndmask_b32 v180, v180, v23, s[10:11]
  s_nop 1
  v_add_f32_dpp v180, v7, v180 quad_perm:[1,0,3,2] row_mask:0xf bank_mask:0xf
  v_cvt_pk_bf16_f32 v180, v180, v180
  v_and_b32 v180, s68, v180
  v_mul_f32 v180, s62, v180
  v_cvt_pk_bf16_f32 v180, v180, v180
  v_and_b32 v180, s68, v180
  s_waitcnt vmcnt(16)
  v_mfma_f32_16x16x32_bf16 v[16:19], a[144:147], v[148:151], 0
  v_mfma_f32_16x16x32_bf16 v[20:23], a[152:155], v[148:151], 0
  v_mfma_f32_16x16x32_bf16 v[16:19], a[148:151], v[152:155], v[16:19]
  v_mfma_f32_16x16x32_bf16 v[20:23], a[156:159], v[152:155], v[20:23]
  s_cmp_le_i32 s14, 2
  s_cbranch_scc1 L_vs30
  buffer_load_dwordx4 a[224:227], v146, s[28:31], s51 offen offset:0 nt
  buffer_load_dwordx4 a[228:231], v146, s[28:31], s51 offen offset:128 nt
  buffer_load_dwordx4 a[232:235], v146, s[28:31], s51 offen offset:2048 nt
  buffer_load_dwordx4 a[236:239], v146, s[28:31], s51 offen offset:2176 nt
L_vj30:
  s_xor_b32 s51, s52, 0xde5000
  v_cndmask_b32 v7, v18, v17, s[16:17]
  v_cndmask_b32 v7, v7, v22, s[18:19]
  v_cndmask_b32 v7, v7, v21, s[10:11]
  v_cndmask_b32 v181, v16, v19, s[16:17]
  v_cndmask_b32 v181, v181, v20, s[18:19]
  v_cndmask_b32 v181, v181, v23, s[10:11]
  s_nop 1
  v_add_f32_dpp v181, v7, v181 quad_perm:[1,0,3,2] row_mask:0xf bank_mask:0xf
  v_cvt_pk_bf16_f32 v181, v181, v181
  v_and_b32 v181, s68, v181
  v_mul_f32 v181, s62, v181
  v_cvt_pk_bf16_f32 v181, v181, v181
  v_and_b32 v181, s68, v181
  v_max3_f32 v5, v5, v180, v181
  s_waitcnt vmcnt(16)
  v_mfma_f32_16x16x32_bf16 v[16:19], a[160:163], v[148:151], 0
  v_mfma_f32_16x16x32_bf16 v[20:23], a[168:171], v[148:151], 0
  v_mfma_f32_16x16x32_bf16 v[16:19], a[164:167], v[152:155], v[16:19]
  v_mfma_f32_16x16x32_bf16 v[20:23], a[172:175], v[152:155], v[20:23]
  buffer_load_dwordx4 a[240:243], v146, s[28:31], s51 offen offset:0 nt
  buffer_load_dwordx4 a[244:247], v146, s[28:31], s51 offen offset:128 nt
  buffer_load_dwordx4 a[248:251], v146, s[28:31], s51 offen offset:2048 nt
  buffer_load_dwordx4 a[252:255], v146, s[28:31], s51 offen offset:2176 nt
  s_xor_b32 s51, s52, 0x0
  s_nop 1
  v_cndmask_b32 v7, v18, v17, s[16:17]
  v_cndmask_b32 v7, v7, v22, s[18:19]
  v_cndmask_b32 v7, v7, v21, s[10:11]
  v_cndmask_b32 v182, v16, v19, s[16:17]
  v_cndmask_b32 v182, v182, v20, s[18:19]
  v_cndmask_b32 v182, v182, v23, s[10:11]
  s_nop 1
  v_add_f32_dpp v182, v7, v182 quad_perm:[1,0,3,2] row_mask:0xf bank_mask:0xf
  v_cvt_pk_bf16_f32 v182, v182, v182
  v_and_b32 v182, s68, v182
  v_mul_f32 v182, s62, v182
  v_cvt_pk_bf16_f32 v182, v182, v182
  v_and_b32 v182, s68, v182
  s_waitcnt vmcnt(16)
  v_mfma_f32_16x16x32_bf16 v[16:19], a[176:179], v[148:151], 0
  v_mfma_f32_16x16x32_bf16 v[20:23], a[184:187], v[148:151], 0
  v_mfma_f32_16x16x32_bf16 v[16:19], a[180:183], v[152:155], v[16:19]
  v_mfma_f32_16x16x32_bf16 v[20:23], a[188:191], v[152:155], v[20:23]
  buffer_load_dwordx2 a[0:1], v145, s[32:35], s51 offen offset:0 nt
  buffer_load_dwordx2 a[2:3], v145, s[32:35], s51 offen offset:8 nt
  buffer_load_dwordx2 a[4:5], v145, s[32:35], s51 offen offset:1024 nt
  buffer_load_dwordx2 a[6:7], v145, s[32:35], s51 offen offset:1032 nt
  buffer_load_dwordx2 a[8:9], v145, s[32:35], s51 offen offset:2048 nt
  buffer_load_dwordx2 a[10:11], v145, s[32:35], s51 offen offset:2056 nt
  buffer_load_dwordx2 a[12:13], v145, s[32:35], s51 offen offset:3072 nt
  buffer_load_dwordx2 a[14:15], v145, s[32:35], s51 offen offset:3080 nt
  s_xor_b32 s51, s52, 0x101000
  v_cndmask_b32 v7, v18, v17, s[16:17]
  v_cndmask_b32 v7, v7, v22, s[18:19]
  v_cndmask_b32 v7, v7, v21, s[10:11]
  v_cndmask_b32 v183, v16, v19, s[16:17]
  v_cndmask_b32 v183, v183, v20, s[18:19]
  v_cndmask_b32 v183, v183, v23, s[10:11]
  s_nop 1
  v_add_f32_dpp v183, v7, v183 quad_perm:[1,0,3,2] row_mask:0xf bank_mask:0xf
  v_cvt_pk_bf16_f32 v183, v183, v183
  v_and_b32 v183, s68, v183
  v_mul_f32 v183, s62, v183
  v_cvt_pk_bf16_f32 v183, v183, v183
  v_and_b32 v183, s68, v183
  v_max3_f32 v5, v5, v182, v183
  s_waitcnt vmcnt(20)
  v_mfma_f32_16x16x32_bf16 v[16:19], a[192:195], v[148:151], 0
  v_mfma_f32_16x16x32_bf16 v[20:23], a[200:203], v[148:151], 0
  v_mfma_f32_16x16x32_bf16 v[16:19], a[196:199], v[152:155], v[16:19]
  v_mfma_f32_16x16x32_bf16 v[20:23], a[204:207], v[152:155], v[20:23]
  buffer_load_dwordx4 a[16:19], v145, s[32:35], s51 offen offset:0 nt
  buffer_load_dwordx4 a[20:23], v145, s[32:35], s51 offen offset:1024 nt
  buffer_load_dwordx4 a[24:27], v145, s[32:35], s51 offen offset:2048 nt
  buffer_load_dwordx4 a[28:31], v145, s[32:35], s51 offen offset:3072 nt
  s_xor_b32 s51, s52, 0x810000
  s_nop 1
  v_cndmask_b32 v7, v18, v17, s[16:17]
  v_cndmask_b32 v7, v7, v22, s[18:19]
  v_cndmask_b32 v7, v7, v21, s[10:11]
  v_cndmask_b32 v184, v16, v19, s[16:17]
  v_cndmask_b32 v184, v184, v20, s[18:19]
  v_cndmask_b32 v184, v184, v23, s[10:11]
  s_nop 1
  v_add_f32_dpp v184, v7, v184 quad_perm:[1,0,3,2] row_mask:0xf bank_mask:0xf
  v_cvt_pk_bf16_f32 v184, v184, v184
  v_and_b32 v184, s68, v184
  v_mul_f32 v184, s62, v184
  v_cvt_pk_bf16_f32 v184, v184, v184
  v_and_b32 v184, s68, v184
  s_waitcnt vmcnt(20)
  v_mfma_f32_16x16x32_bf16 v[16:19], a[208:211], v[148:151], 0
  v_mfma_f32_16x16x32_bf16 v[20:23], a[216:219], v[148:151], 0
  v_mfma_f32_16x16x32_bf16 v[16:19], a[212:215], v[152:155], v[16:19]
  v_mfma_f32_16x16x32_bf16 v[20:23], a[220:223], v[152:155], v[20:23]
  buffer_load_dwordx2 a[32:33], v145, s[32:35], s51 offen offset:0 nt
  buffer_load_dwordx2 a[34:35], v145, s[32:35], s51 offen offset:8 nt
  buffer_load_dwordx2 a[36:37], v145, s[32:35], s51 offen offset:1024 nt
  buffer_load_dwordx2 a[38:39], v145, s[32:35], s51 offen offset:1032 nt
  buffer_load_dwordx2 a[40:41], v145, s[32:35], s51 offen offset:2048 nt
  buffer_load_dwordx2 a[42:43], v145, s[32:35], s51 offen offset:2056 nt
  buffer_load_dwordx2 a[44:45], v145, s[32:35], s51 offen offset:3072 nt
  buffer_load_dwordx2 a[46:47], v145, s[32:35], s51 offen offset:3080 nt
  s_xor_b32 s51, s52, 0x911000
  v_cndmask_b32 v7, v18, v17, s[16:17]
  v_cndmask_b32 v7, v7, v22, s[18:19]
  v_cndmask_b32 v7, v7, v21, s[10:11]
  v_cndmask_b32 v185, v16, v19, s[16:17]
  v_cndmask_b32 v185, v185, v20, s[18:19]
  v_cndmask_b32 v185, v185, v23, s[10:11]
  s_nop 1
  v_add_f32_dpp v185, v7, v185 quad_perm:[1,0,3,2] row_mask:0xf bank_mask:0xf
  v_cvt_pk_bf16_f32 v185, v185, v185
  v_and_b32 v185, s68, v185
  v_mul_f32 v185, s62, v185
  v_cvt_pk_bf16_f32 v185, v185, v185
  v_and_b32 v185, s68, v185
  v_max3_f32 v5, v5, v184, v185
  s_waitcnt vmcnt(24)
  v_mfma_f32_16x16x32_bf16 v[16:19], a[224:227], v[148:151], 0
  v_mfma_f32_16x16x32_bf16 v[20:23], a[232:235], v[148:151], 0
  v_mfma_f32_16x16x32_bf16 v[16:19], a[228:231], v[152:155], v[16:19]
  v_mfma_f32_16x16x32_bf16 v[20:23], a[236:239], v[152:155], v[20:23]
  buffer_load_dwordx4 a[48:51], v145, s[32:35], s51 offen offset:0 nt
  buffer_load_dwordx4 a[52:55], v145, s[32:35], s51 offen offset:1024 nt
  buffer_load_dwordx4 a[56:59], v145, s[32:35], s51 offen offset:2048 nt
  buffer_load_dwordx4 a[60:63], v145, s[32:35], s51 offen offset:3072 nt
  s_xor_b32 s51, s52, 0x484000
  s_nop 1
  v_cndmask_b32 v7, v18, v17, s[16:17]
  v_cndmask_b32 v7, v7, v22, s[18:19]
  v_cndmask_b32 v7, v7, v21, s[10:11]
  v_cndmask_b32 v186, v16, v19, s[16:17]
  v_cndmask_b32 v186, v186, v20, s[18:19]
  v_cndmask_b32 v186, v186, v23, s[10:11]
  s_nop 1
  v_add_f32_dpp v186, v7, v186 quad_perm:[1,0,3,2] row_mask:0xf bank_mask:0xf
  v_cvt_pk_bf16_f32 v186, v186, v186
  v_and_b32 v186, s68, v186
  v_mul_f32 v186, s62, v186
  v_cvt_pk_bf16_f32 v186, v186, v186
  v_and_b32 v186, s68, v186
  s_waitcnt vmcnt(24)
  v_mfma_f32_16x16x32_bf16 v[16:19], a[240:243], v[148:151], 0
  v_mfma_f32_16x16x32_bf16 v[20:23], a[248:251], v[148:151], 0
  v_mfma_f32_16x16x32_bf16 v[16:19], a[244:247], v[152:155], v[16:19]
  v_mfma_f32_16x16x32_bf16 v[20:23], a[252:255], v[152:155], v[20:23]
  buffer_load_dwordx2 a[64:65], v145, s[32:35], s51 offen offset:0 nt
  buffer_load_dwordx2 a[66:67], v145, s[32:35], s51 offen offset:8 nt
  buffer_load_dwordx2 a[68:69], v145, s[32:35], s51 offen offset:1024 nt
  buffer_load_dwordx2 a[70:71], v145, s[32:35], s51 offen offset:1032 nt
  buffer_load_dwordx2 a[72:73], v145, s[32:35], s51 offen offset:2048 nt
  buffer_load_dwordx2 a[74:75], v145, s[32:35], s51 offen offset:2056 nt
  buffer_load_dwordx2 a[76:77], v145, s[32:35], s51 offen offset:3072 nt
  buffer_load_dwordx2 a[78:79], v145, s[32:35], s51 offen offset:3080 nt
  s_xor_b32 s51, s52, 0x585000
  v_cndmask_b32 v7, v18, v17, s[16:17]
  v_cndmask_b32 v7, v7, v22, s[18:19]
  v_cndmask_b32 v7, v7, v21, s[10:11]
  v_cndmask_b32 v187, v16, v19, s[16:17]
  v_cndmask_b32 v187, v187, v20, s[18:19]
  v_cndmask_b32 v187, v187, v23, s[10:11]
  s_nop 1
  v_add_f32_dpp v187, v7, v187 quad_perm:[1,0,3,2] row_mask:0xf bank_mask:0xf
  v_cvt_pk_bf16_f32 v187, v187, v187
  v_and_b32 v187, s68, v187
  v_mul_f32 v187, s62, v187
  v_cvt_pk_bf16_f32 v187, v187, v187
  v_and_b32 v187, s68, v187
  v_max3_f32 v5, v5, v186, v187
  s_nop 1
  v_max_f32_dpp v5, v5, v5 quad_perm:[1,0,3,2] row_mask:0xf bank_mask:0xf
  s_nop 1
  v_max_f32_dpp v5, v5, v5 quad_perm:[2,3,0,1] row_mask:0xf bank_mask:0xf
  v_mov_b32 v7, v5
  s_nop 1
  v_permlane16_swap_b32 v5, v7
  v_max_f32 v5, v5, v7
  v_mov_b32 v7, v5
  s_nop 1
  v_permlane32_swap_b32 v5, v7
  v_max_f32 v5, v5, v7
  v_xor_b32 v5, 0x80000000, v5
  v_add_f32 v156, v156, v5
  v_add_f32 v157, v157, v5
  v_add_f32 v158, v158, v5
  v_add_f32 v159, v159, v5
  v_mul_f32 v156, s63, v156
  v_mul_f32 v157, s63, v157
  v_mul_f32 v158, s63, v158
  v_mul_f32 v159, s63, v159
  v_exp_f32 v156, v156
  v_exp_f32 v157, v157
  v_exp_f32 v158, v158
  v_exp_f32 v159, v159
  v_add_f32 v6, v156, v157
  v_add_f32 v63, v158, v159
  v_add_f32 v160, v160, v5
  v_add_f32 v161, v161, v5
  v_add_f32 v162, v162, v5
  v_add_f32 v163, v163, v5
  v_mul_f32 v160, s63, v160
  v_mul_f32 v161, s63, v161
  v_mul_f32 v162, s63, v162
  v_mul_f32 v163, s63, v163
  v_exp_f32 v160, v160
  v_exp_f32 v161, v161
  v_exp_f32 v162, v162
  v_exp_f32 v163, v163
  v_add_f32 v63, v63, v160
  v_add_f32 v6, v6, v161
  v_add_f32 v63, v63, v162
  v_add_f32 v6, v6, v163
  v_add_f32 v164, v164, v5
  v_add_f32 v165, v165, v5
  v_add_f32 v166, v166, v5
  v_add_f32 v167, v167, v5
  v_mul_f32 v164, s63, v164
  v_mul_f32 v165, s63, v165
  v_mul_f32 v166, s63, v166
  v_mul_f32 v167, s63, v167
  v_exp_f32 v164, v164
  v_exp_f32 v165, v165
  v_exp_f32 v166, v166
  v_exp_f32 v167, v167
  v_add_f32 v63, v63, v164
  v_add_f32 v6, v6, v165
  v_add_f32 v63, v63, v166
  v_add_f32 v6, v6, v167
  v_add_f32 v168, v168, v5
  v_add_f32 v169, v169, v5
  v_add_f32 v170, v170, v5
  v_add_f32 v171, v171, v5
  v_mul_f32 v168, s63, v168
  v_mul_f32 v169, s63, v169
  v_mul_f32 v170, s63, v170
  v_mul_f32 v171, s63, v171
  v_exp_f32 v168, v168
  v_exp_f32 v169, v169
  v_exp_f32 v170, v170
  v_exp_f32 v171, v171
  v_add_f32 v63, v63, v168
  v_add_f32 v6, v6, v169
  v_add_f32 v63, v63, v170
  v_add_f32 v6, v6, v171
  v_add_f32 v172, v172, v5
  v_add_f32 v173, v173, v5
  v_add_f32 v174, v174, v5
  v_add_f32 v175, v175, v5
  v_mul_f32 v172, s63, v172
  v_mul_f32 v173, s63, v173
  v_mul_f32 v174, s63, v174
  v_mul_f32 v175, s63, v175
  v_exp_f32 v172, v172
  v_exp_f32 v173, v173
  v_exp_f32 v174, v174
  v_exp_f32 v175, v175
  v_add_f32 v63, v63, v172
  v_add_f32 v6, v6, v173
  v_add_f32 v63, v63, v174
  v_add_f32 v6, v6, v175
  v_add_f32 v176, v176, v5
  v_add_f32 v177, v177, v5
  v_add_f32 v178, v178, v5
  v_add_f32 v179, v179, v5
  v_mul_f32 v176, s63, v176
  v_mul_f32 v177, s63, v177
  v_mul_f32 v178, s63, v178
  v_mul_f32 v179, s63, v179
  v_exp_f32 v176, v176
  v_exp_f32 v177, v177
  v_exp_f32 v178, v178
  v_exp_f32 v179, v179
  v_add_f32 v63, v63, v176
  v_add_f32 v6, v6, v177
  v_add_f32 v63, v63, v178
  v_add_f32 v6, v6, v179
  v_add_f32 v180, v180, v5
  v_add_f32 v181, v181, v5
  v_add_f32 v182, v182, v5
  v_add_f32 v183, v183, v5
  v_mul_f32 v180, s63, v180
  v_mul_f32 v181, s63, v181
  v_mul_f32 v182, s63, v182
  v_mul_f32 v183, s63, v183
  v_exp_f32 v180, v180
  v_exp_f32 v181, v181
  v_exp_f32 v182, v182
  v_exp_f32 v183, v183
  v_add_f32 v63, v63, v180
  v_add_f32 v6, v6, v181
  v_add_f32 v63, v63, v182
  v_add_f32 v6, v6, v183
  v_add_f32 v184, v184, v5
  v_add_f32 v185, v185, v5
  v_add_f32 v186, v186, v5
  v_add_f32 v187, v187, v5
  v_mul_f32 v184, s63, v184
  v_mul_f32 v185, s63, v185
  v_mul_f32 v186, s63, v186
  v_mul_f32 v187, s63, v187
  v_exp_f32 v184, v184
  v_exp_f32 v185, v185
  v_exp_f32 v186, v186
  v_exp_f32 v187, v187
  v_add_f32 v63, v63, v184
  v_add_f32 v6, v6, v185
  v_add_f32 v63, v63, v186
  v_add_f32 v6, v6, v187
  v_add_f32 v6, v6, v63
  s_nop 1
  v_add_f32_dpp v6, v6, v6 quad_perm:[1,0,3,2] row_mask:0xf bank_mask:0xf
  s_nop 1
  v_add_f32_dpp v6, v6, v6 quad_perm:[2,3,0,1] row_mask:0xf bank_mask:0xf
  v_mov_b32 v7, v6
  s_nop 1
  v_permlane16_swap_b32 v6, v7
  v_add_f32 v6, v6, v7
  v_mov_b32 v7, v6
  s_nop 1
  v_permlane32_swap_b32 v6, v7
  v_add_f32 v6, v6, v7
  ds_write2_b32 v55, v5, v6 offset0:0 offset1:16
  v_lshlrev_b32 v189, 2, v0
  v_mov_b32 v190, 1
  v_mov_b32 v7, 0
  ds_write_b32 v189, v7 offset:18944
  s_waitcnt lgkmcnt(0)
  s_barrier
  ds_read_b32 v63, v7 offset:4096
  s_waitcnt lgkmcnt(0)
  v_readfirstlane_b32 s58, v63
  s_cmp_lg_u32 s48, 3
  s_cbranch_scc1 L_noypub
  s_cmp_ge_u32 s50, 28
  s_cbranch_scc1 L_noypub
  s_mov_b64 exec, 0xffff
  s_lshl_b32 s56, s50, 11
  s_lshl_b32 s57, s49, 8
  s_add_u32 s56, s56, s57
  s_add_u32 s56, s56, 65536
  ds_read_b128 v[64:67], v2 offset:2048
  ds_read_b128 v[68:71], v2 offset:2304
  ds_read_b128 v[72:75], v2 offset:2560
  ds_read_b128 v[76:79], v2 offset:2816
  ds_read_b128 v[80:83], v2 offset:3072
  ds_read_b128 v[84:87], v2 offset:3328
  ds_read_b128 v[88:91], v2 offset:3584
  ds_read_b128 v[92:95], v2 offset:3840
  s_waitcnt lgkmcnt(0)
  v_pk_add_f32 v[64:65], v[64:65], v[80:81]
  v_pk_add_f32 v[66:67], v[66:67], v[82:83]
  v_pk_add_f32 v[68:69], v[68:69], v[84:85]
  v_pk_add_f32 v[70:71], v[70:71], v[86:87]
  v_pk_add_f32 v[72:73], v[72:73], v[88:89]
  v_pk_add_f32 v[74:75], v[74:75], v[90:91]
  v_pk_add_f32 v[76:77], v[76:77], v[92:93]
  v_pk_add_f32 v[78:79], v[78:79], v[94:95]
  v_pk_add_f32 v[64:65], v[64:65], v[72:73]
  v_pk_add_f32 v[66:67], v[66:67], v[74:75]
  v_pk_add_f32 v[68:69], v[68:69], v[76:77]
  v_pk_add_f32 v[70:71], v[70:71], v[78:79]
  v_pk_add_f32 v[64:65], v[64:65], v[68:69]
  v_pk_add_f32 v[66:67], v[66:67], v[70:71]
  v_add_u32 v64, 0x80, v64
  v_add_u32 v65, 0x80, v65
  v_add_u32 v66, 0x80, v66
  v_add_u32 v67, 0x80, v67
  v_bfi_b32 v64, v52, s64, v64
  v_bfi_b32 v65, v52, s65, v65
  v_bfi_b32 v66, v52, s66, v66
  v_bfi_b32 v67, v52, s67, v67
  s_cmp_eq_u32 s58, 0
  s_cbranch_scc1 L_yslow
  buffer_store_dwordx4 v[64:67], v2, s[40:43], s56 offen
L_ydone:
  s_mov_b64 exec, -1
L_noypub:
  s_cmp_lg_u32 s48, 0
  s_cbranch_scc1 L_nomlpub
  ds_read_b128 v[16:19], v56 offset:4224
  ds_read_b128 v[20:23], v56 offset:4288
  s_waitcnt lgkmcnt(0)
  v_min3_f32 v12, v16, v17, v18
  v_min_f32 v12, v12, v19
  v_sub_f32 v16, v12, v16
  v_sub_f32 v17, v12, v17
  v_sub_f32 v18, v12, v18
  v_sub_f32 v19, v12, v19
  v_mul_f32 v16, s63, v16
  v_mul_f32 v17, s63, v17
  v_mul_f32 v18, s63, v18
  v_mul_f32 v19, s63, v19
  v_exp_f32 v16, v16
  v_exp_f32 v17, v17
  v_exp_f32 v18, v18
  v_exp_f32 v19, v19
  v_mov_b32 v14, s55
  v_mov_b32 v15, s55
  v_mul_f32 v13, v16, v20
  v_fmac_f32 v13, v17, v21
  v_fmac_f32 v13, v18, v22
  v_fmac_f32 v13, v19, v23
  s_mov_b64 exec, 0xf
  s_cmp_eq_u32 s58, 0
  s_cbranch_scc1 L_mlslow
  buffer_store_dwordx4 v[12:15], v2, s[40:43], s76 offen
L_mldone:
  s_mov_b64 exec, -1
L_nomlpub:
  s_barrier
  buffer_load_dwordx4 a[80:83], v145, s[32:35], s51 offen offset:0 nt
  buffer_load_dwordx4 a[84:87], v145, s[32:35], s51 offen offset:1024 nt
  buffer_load_dwordx4 a[88:91], v145, s[32:35], s51 offen offset:2048 nt
  buffer_load_dwordx4 a[92:95], v145, s[32:35], s51 offen offset:3072 nt
  s_xor_b32 s51, s52, 0xc94000
  s_lshl_b32 s56, s49, 9
  s_add_u32 s56, s56, 196864
  s_cmp_lg_u32 s48, 3
  s_cbranch_scc1 L_noflag1
  s_lshl_b32 s57, s50, 2
  s_add_u32 s57, s57, s56
  v_mov_b32 v134, s55
  s_mov_b64 exec, 1
  buffer_store_dword v134, v2, s[40:43], s57 offen
  s_mov_b64 exec, -1
L_noflag1:
  v_and_b32 v135, 31, v0
  v_lshlrev_b32 v135, 2, v135
  buffer_load_dword v104, v135, s[40:43], s56 offen sc1
  buffer_load_dwordx2 a[96:97], v145, s[32:35], s51 offen offset:0 nt
  buffer_load_dwordx2 a[98:99], v145, s[32:35], s51 offen offset:8 nt
  buffer_load_dwordx2 a[100:101], v145, s[32:35], s51 offen offset:1024 nt
  buffer_load_dwordx2 a[102:103], v145, s[32:35], s51 offen offset:1032 nt
  buffer_load_dwordx2 a[104:105], v145, s[32:35], s51 offen offset:2048 nt
  buffer_load_dwordx2 a[106:107], v145, s[32:35], s51 offen offset:2056 nt
  buffer_load_dwordx2 a[108:109], v145, s[32:35], s51 offen offset:3072 nt
  buffer_load_dwordx2 a[110:111], v145, s[32:35], s51 offen offset:3080 nt
  s_xor_b32 s51, s52, 0xd95000
  buffer_load_dwordx4 a[112:115], v145, s[32:35], s51 offen offset:0 nt
  buffer_load_dwordx4 a[116:119], v145, s[32:35], s51 offen offset:1024 nt
  buffer_load_dwordx4 a[120:123], v145, s[32:35], s51 offen offset:2048 nt
  buffer_load_dwordx4 a[124:127], v145, s[32:35], s51 offen offset:3072 nt
  s_xor_b32 s51, s52, 0x20000
  buffer_load_dwordx4 a[128:131], v145, s[32:35], s51 offen offset:0 nt
  buffer_load_dwordx4 a[132:135], v145, s[32:35], s51 offen offset:1024 nt
  buffer_load_dwordx4 a[136:139], v145, s[32:35], s51 offen offset:2048 nt
  buffer_load_dwordx4 a[140:143], v145, s[32:35], s51 offen offset:3072 nt
  s_xor_b32 s51, s52, 0x121000
  s_waitcnt vmcnt(16)
  v_cmp_eq_u32 vcc, s55, v104
  s_bcnt1_i32_b32 s56, vcc_lo
  s_mov_b32 s14, 1
  s_cmp_gt_u32 s56, 0
  s_addc_u32 s14, s14, 0
  s_cmp_gt_u32 s56, 6
  s_addc_u32 s14, s14, 0
  s_cmp_gt_u32 s56, 12
  s_addc_u32 s14, s14, 0
  s_cmp_gt_u32 s56, 24
  s_addc_u32 s14, s14, 0
  s_cmp_gt_u32 s56, 29
  s_addc_u32 s14, s14, 0
  s_cmp_gt_u32 s56, 31
  s_addc_u32 s14, s14, 0
  s_cmp_le_i32 s14, 5
  s_cbranch_scc1 L_vs41
  buffer_load_dwordx4 a[144:147], v145, s[32:35], s51 offen offset:0 nt
  buffer_load_dwordx4 a[148:151], v145, s[32:35], s51 offen offset:1024 nt
  buffer_load_dwordx4 a[152:155], v145, s[32:35], s51 offen offset:2048 nt
  buffer_load_dwordx4 a[156:159], v145, s[32:35], s51 offen offset:3072 nt
L_vj41:
  s_xor_b32 s51, s52, 0x830000
  buffer_load_dwordx4 a[160:163], v145, s[32:35], s51 offen offset:0 nt
  buffer_load_dwordx4 a[164:167], v145, s[32:35], s51 offen offset:1024 nt
  buffer_load_dwordx4 a[168:171], v145, s[32:35], s51 offen offset:2048 nt
  buffer_load_dwordx4 a[172:175], v145, s[32:35], s51 offen offset:3072 nt
  s_xor_b32 s51, s52, 0x931000
  s_cmp_ge_u32 s74, 128
  s_cbranch_scc1 L_noyget
  v_mov_b32 v44, 0
  v_mov_b32 v45, 0
  v_mov_b32 v46, 0
  v_mov_b32 v47, 0
  s_add_u32 s56, s73, 0
  buffer_load_dwordx4 v[32:35], v60, s[40:43], s56 offen sc1
  s_add_u32 s56, s73, 16384
  buffer_load_dwordx4 v[36:39], v60, s[40:43], s56 offen sc1
  s_add_u32 s56, s73, 32768
  buffer_load_dwordx4 v[40:43], v60, s[40:43], s56 offen sc1
  s_mov_b32 exec_hi, 0
  s_add_u32 s56, s73, 49152
  buffer_load_dwordx4 v[44:47], v60, s[40:43], s56 offen sc1
  s_mov_b64 exec, -1
L_noyget:
  buffer_load_dwordx4 v[64:67], v58, s[40:43], s3 offen
  buffer_load_dwordx4 v[68:71], v58, s[40:43], s3 offen offset:1024
  s_cmp_le_i32 s14, 0
  s_cbranch_scc1 L_vs43
  buffer_load_dwordx4 a[176:179], v145, s[32:35], s51 offen offset:0 nt
  buffer_load_dwordx4 a[180:183], v145, s[32:35], s51 offen offset:1024 nt
  buffer_load_dwordx4 a[184:187], v145, s[32:35], s51 offen offset:2048 nt
  buffer_load_dwordx4 a[188:191], v145, s[32:35], s51 offen offset:3072 nt
L_vj43:
  s_xor_b32 s51, s52, 0x4a4000
  s_cmp_le_i32 s14, 4
  s_cbranch_scc1 L_vs44
  buffer_load_dwordx4 a[192:195], v145, s[32:35], s51 offen offset:0 nt
  buffer_load_dwordx4 a[196:199], v145, s[32:35], s51 offen offset:1024 nt
  buffer_load_dwordx4 a[200:203], v145, s[32:35], s51 offen offset:2048 nt
  buffer_load_dwordx4 a[204:207], v145, s[32:35], s51 offen offset:3072 nt
L_vj44:
  s_xor_b32 s51, s52, 0x5a5000
  s_cmp_le_i32 s14, 1
  s_cbranch_scc1 L_vs45
  buffer_load_dwordx4 a[208:211], v145, s[32:35], s51 offen offset:0 nt
  buffer_load_dwordx4 a[212:215], v145, s[32:35], s51 offen offset:1024 nt
  buffer_load_dwordx4 a[216:219], v145, s[32:35], s51 offen offset:2048 nt
  buffer_load_dwordx4 a[220:223], v145, s[32:35], s51 offen offset:3072 nt
L_vj45:
  s_xor_b32 s51, s52, 0xcb4000
  s_cmp_le_i32 s14, 3
  s_cbranch_scc1 L_vs46
  buffer_load_dwordx4 a[224:227], v145, s[32:35], s51 offen offset:0 nt
  buffer_load_dwordx4 a[228:231], v145, s[32:35], s51 offen offset:1024 nt
  buffer_load_dwordx4 a[232:235], v145, s[32:35], s51 offen offset:2048 nt
  buffer_load_dwordx4 a[236:239], v145, s[32:35], s51 offen offset:3072 nt
L_vj46:
  s_xor_b32 s51, s52, 0xdb5000
  s_cmp_le_i32 s14, 2
  s_cbranch_scc1 L_vs47
  buffer_load_dwordx4 a[240:243], v145, s[32:35], s51 offen offset:0 nt
  buffer_load_dwordx4 a[244:247], v145, s[32:35], s51 offen offset:1024 nt
  buffer_load_dwordx4 a[248:251], v145, s[32:35], s51 offen offset:2048 nt
  buffer_load_dwordx4 a[252:255], v145, s[32:35], s51 offen offset:3072 nt
L_vj47:
  s_xor_b32 s51, s52, 0x50000
  s_waitcnt vmcnt(20)
L_mchk:
  v_xor_b32 v7, s55, v66
  v_xor_b32 v63, s55, v70
  v_or_b32 v7, v7, v63
  v_cmp_ne_u32 vcc, 0, v7
  s_cbranch_vccnz L_mretry
L_mok:
  v_min_f32 v63, v64, v68
  s_nop 1
  v_min_f32_dpp v63, v63, v63 quad_perm:[1,0,3,2] row_mask:0xf bank_mask:0xf
  s_nop 1
  v_min_f32_dpp v63, v63, v63 quad_perm:[2,3,0,1] row_mask:0xf bank_mask:0xf
  v_mov_b32 v7, v63
  s_nop 1
  v_permlane16_swap_b32 v63, v7
  v_min_f32 v63, v63, v7
  v_mov_b32 v7, v63
  s_nop 1
  v_permlane32_swap_b32 v63, v7
  v_min_f32 v63, v63, v7
  v_sub_f32 v64, v63, v64
  v_sub_f32 v68, v63, v68
  v_sub_f32 v5, v63, v5
  v_mul_f32 v64, s63, v64
  v_mul_f32 v68, s63, v68
  v_mul_f32 v5, s63, v5
  v_exp_f32 v64, v64
  v_exp_f32 v68, v68
  v_exp_f32 v5, v5
  v_mul_f32 v6, v64, v65
  v_fmac_f32 v6, v68, v69
  s_nop 1
  v_add_f32_dpp v6, v6, v6 quad_perm:[1,0,3,2] row_mask:0xf bank_mask:0xf
  s_nop 1
  v_add_f32_dpp v6, v6, v6 quad_perm:[2,3,0,1] row_mask:0xf bank_mask:0xf
  v_mov_b32 v7, v6
  s_nop 1
  v_permlane16_swap_b32 v6, v7
  v_add_f32 v6, v6, v7
  v_mov_b32 v7, v6
  s_nop 1
  v_permlane32_swap_b32 v6, v7
  v_add_f32 v6, v6, v7
  v_rcp_f32 v6, v6
  s_nop 0
  v_mul_f32 v5, v5, v6
  v_mul_f32 v156, v156, v5
  v_cvt_pk_bf16_f32 v156, v156, v156
  v_mul_f32 v157, v157, v5
  v_cvt_pk_bf16_f32 v157, v157, v157
  v_and_b32_dpp v24, v156, v3 quad_perm:[0,0,0,0] row_mask:0xf bank_mask:0xf
  v_and_b32_dpp v25, v156, v4 quad_perm:[0,0,0,0] row_mask:0xf bank_mask:0xf
  v_and_b32_dpp v26, v156, v3 quad_perm:[1,1,1,1] row_mask:0xf bank_mask:0xf
  v_and_b32_dpp v27, v156, v4 quad_perm:[1,1,1,1] row_mask:0xf bank_mask:0xf
  v_and_b32_dpp v28, v156, v3 quad_perm:[2,2,2,2] row_mask:0xf bank_mask:0xf
  v_and_b32_dpp v29, v156, v4 quad_perm:[2,2,2,2] row_mask:0xf bank_mask:0xf
  v_and_b32_dpp v30, v156, v3 quad_perm:[3,3,3,3] row_mask:0xf bank_mask:0xf
  v_and_b32_dpp v31, v156, v4 quad_perm:[3,3,3,3] row_mask:0xf bank_mask:0xf
  v_mfma_f32_16x16x16_bf16 v[8:11], v[24:25], a[0:1], 0
  v_mfma_f32_16x16x16_bf16 v[12:15], v[24:25], a[2:3], 0
  v_mfma_f32_16x16x16_bf16 v[8:11], v[26:27], a[4:5], v[8:11]
  v_mfma_f32_16x16x16_bf16 v[12:15], v[26:27], a[6:7], v[12:15]
  v_mfma_f32_16x16x16_bf16 v[8:11], v[28:29], a[8:9], v[8:11]
  v_mfma_f32_16x16x16_bf16 v[12:15], v[28:29], a[10:11], v[12:15]
  v_mfma_f32_16x16x16_bf16 v[8:11], v[30:31], a[12:13], v[8:11]
  v_mfma_f32_16x16x16_bf16 v[12:15], v[30:31], a[14:15], v[12:15]
  buffer_load_dwordx2 a[0:1], v145, s[32:35], s51 offen offset:0 nt
  buffer_load_dwordx2 a[2:3], v145, s[32:35], s51 offen offset:8 nt
  buffer_load_dwordx2 a[4:5], v145, s[32:35], s51 offen offset:1024 nt
  buffer_load_dwordx2 a[6:7], v145, s[32:35], s51 offen offset:1032 nt
  buffer_load_dwordx2 a[8:9], v145, s[32:35], s51 offen offset:2048 nt
  buffer_load_dwordx2 a[10:11], v145, s[32:35], s51 offen offset:2056 nt
  buffer_load_dwordx2 a[12:13], v145, s[32:35], s51 offen offset:3072 nt
  buffer_load_dwordx2 a[14:15], v145, s[32:35], s51 offen offset:3080 nt
  s_xor_b32 s51, s52, 0x151000
  v_mul_f32 v158, v158, v5
  v_cvt_pk_bf16_f32 v158, v158, v158
  v_and_b32_dpp v24, v157, v3 quad_perm:[0,0,0,0] row_mask:0xf bank_mask:0xf
  v_and_b32_dpp v25, v157, v4 quad_perm:[0,0,0,0] row_mask:0xf bank_mask:0xf
  v_and_b32_dpp v26, v157, v3 quad_perm:[1,1,1,1] row_mask:0xf bank_mask:0xf
  v_and_b32_dpp v27, v157, v4 quad_perm:[1,1,1,1] row_mask:0xf bank_mask:0xf
  v_and_b32_dpp v28, v157, v3 quad_perm:[2,2,2,2] row_mask:0xf bank_mask:0xf
  v_and_b32_dpp v29, v157, v4 quad_perm:[2,2,2,2] row_mask:0xf bank_mask:0xf
  v_and_b32_dpp v30, v157, v3 quad_perm:[3,3,3,3] row_mask:0xf bank_mask:0xf
  v_and_b32_dpp v31, v157, v4 quad_perm:[3,3,3,3] row_mask:0xf bank_mask:0xf
  v_mfma_f32_16x16x16_bf16 v[8:11], v[24:25], a[16:17], v[8:11]
  v_mfma_f32_16x16x16_bf16 v[12:15], v[24:25], a[18:19], v[12:15]
  v_mfma_f32_16x16x16_bf16 v[8:11], v[26:27], a[20:21], v[8:11]
  v_mfma_f32_16x16x16_bf16 v[12:15], v[26:27], a[22:23], v[12:15]
  v_mfma_f32_16x16x16_bf16 v[8:11], v[28:29], a[24:25], v[8:11]
  v_mfma_f32_16x16x16_bf16 v[12:15], v[28:29], a[26:27], v[12:15]
  v_mfma_f32_16x16x16_bf16 v[8:11], v[30:31], a[28:29], v[8:11]
  v_mfma_f32_16x16x16_bf16 v[12:15], v[30:31], a[30:31], v[12:15]
  v_mul_f32 v159, v159, v5
  v_cvt_pk_bf16_f32 v159, v159, v159
  v_and_b32_dpp v24, v158, v3 quad_perm:[0,0,0,0] row_mask:0xf bank_mask:0xf
  v_and_b32_dpp v25, v158, v4 quad_perm:[0,0,0,0] row_mask:0xf bank_mask:0xf
  v_and_b32_dpp v26, v158, v3 quad_perm:[1,1,1,1] row_mask:0xf bank_mask:0xf
  v_and_b32_dpp v27, v158, v4 quad_perm:[1,1,1,1] row_mask:0xf bank_mask:0xf
  v_and_b32_dpp v28, v158, v3 quad_perm:[2,2,2,2] row_mask:0xf bank_mask:0xf
  v_and_b32_dpp v29, v158, v4 quad_perm:[2,2,2,2] row_mask:0xf bank_mask:0xf
  v_and_b32_dpp v30, v158, v3 quad_perm:[3,3,3,3] row_mask:0xf bank_mask:0xf
  v_and_b32_dpp v31, v158, v4 quad_perm:[3,3,3,3] row_mask:0xf bank_mask:0xf
  v_mfma_f32_16x16x16_bf16 v[8:11], v[24:25], a[32:33], v[8:11]
  v_mfma_f32_16x16x16_bf16 v[12:15], v[24:25], a[34:35], v[12:15]
  v_mfma_f32_16x16x16_bf16 v[8:11], v[26:27], a[36:37], v[8:11]
  v_mfma_f32_16x16x16_bf16 v[12:15], v[26:27], a[38:39], v[12:15]
  v_mfma_f32_16x16x16_bf16 v[8:11], v[28:29], a[40:41], v[8:11]
  v_mfma_f32_16x16x16_bf16 v[12:15], v[28:29], a[42:43], v[12:15]
  v_mfma_f32_16x16x16_bf16 v[8:11], v[30:31], a[44:45], v[8:11]
  v_mfma_f32_16x16x16_bf16 v[12:15], v[30:31], a[46:47], v[12:15]
  buffer_load_dwordx4 a[16:19], v145, s[32:35], s51 offen offset:0 nt
  buffer_load_dwordx4 a[20:23], v145, s[32:35], s51 offen offset:1024 nt
  buffer_load_dwordx4 a[24:27], v145, s[32:35], s51 offen offset:2048 nt
  buffer_load_dwordx4 a[28:31], v145, s[32:35], s51 offen offset:3072 nt
  s_xor_b32 s51, s52, 0x840000
  v_mul_f32 v160, v160, v5
  v_cvt_pk_bf16_f32 v160, v160, v160
  v_and_b32_dpp v24, v159, v3 quad_perm:[0,0,0,0] row_mask:0xf bank_mask:0xf
  v_and_b32_dpp v25, v159, v4 quad_perm:[0,0,0,0] row_mask:0xf bank_mask:0xf
  v_and_b32_dpp v26, v159, v3 quad_perm:[1,1,1,1] row_mask:0xf bank_mask:0xf
  v_and_b32_dpp v27, v159, v4 quad_perm:[1,1,1,1] row_mask:0xf bank_mask:0xf
  v_and_b32_dpp v28, v159, v3 quad_perm:[2,2,2,2] row_mask:0xf bank_mask:0xf
  v_and_b32_dpp v29, v159, v4 quad_perm:[2,2,2,2] row_mask:0xf bank_mask:0xf
  v_and_b32_dpp v30, v159, v3 quad_perm:[3,3,3,3] row_mask:0xf bank_mask:0xf
  v_and_b32_dpp v31, v159, v4 quad_perm:[3,3,3,3] row_mask:0xf bank_mask:0xf
  v_mfma_f32_16x16x16_bf16 v[8:11], v[24:25], a[48:49], v[8:11]
  v_mfma_f32_16x16x16_bf16 v[12:15], v[24:25], a[50:51], v[12:15]
  v_mfma_f32_16x16x16_bf16 v[8:11], v[26:27], a[52:53], v[8:11]
  v_mfma_f32_16x16x16_bf16 v[12:15], v[26:27], a[54:55], v[12:15]
  v_mfma_f32_16x16x16_bf16 v[8:11], v[28:29], a[56:57], v[8:11]
  v_mfma_f32_16x16x16_bf16 v[12:15], v[28:29], a[58:59], v[12:15]
  v_mfma_f32_16x16x16_bf16 v[8:11], v[30:31], a[60:61], v[8:11]
  v_mfma_f32_16x16x16_bf16 v[12:15], v[30:31], a[62:63], v[12:15]
  v_mul_f32 v161, v161, v5
  v_cvt_pk_bf16_f32 v161, v161, v161
  v_and_b32_dpp v24, v160, v3 quad_perm:[0,0,0,0] row_mask:0xf bank_mask:0xf
  v_and_b32_dpp v25, v160, v4 quad_perm:[0,0,0,0] row_mask:0xf bank_mask:0xf
  v_and_b32_dpp v26, v160, v3 quad_perm:[1,1,1,1] row_mask:0xf bank_mask:0xf
  v_and_b32_dpp v27, v160, v4 quad_perm:[1,1,1,1] row_mask:0xf bank_mask:0xf
  v_and_b32_dpp v28, v160, v3 quad_perm:[2,2,2,2] row_mask:0xf bank_mask:0xf
  v_and_b32_dpp v29, v160, v4 quad_perm:[2,2,2,2] row_mask:0xf bank_mask:0xf
  v_and_b32_dpp v30, v160, v3 quad_perm:[3,3,3,3] row_mask:0xf bank_mask:0xf
  v_and_b32_dpp v31, v160, v4 quad_perm:[3,3,3,3] row_mask:0xf bank_mask:0xf
  v_mfma_f32_16x16x16_bf16 v[8:11], v[24:25], a[64:65], v[8:11]
  v_mfma_f32_16x16x16_bf16 v[12:15], v[24:25], a[66:67], v[12:15]
  v_mfma_f32_16x16x16_bf16 v[8:11], v[26:27], a[68:69], v[8:11]
  v_mfma_f32_16x16x16_bf16 v[12:15], v[26:27], a[70:71], v[12:15]
  v_mfma_f32_16x16x16_bf16 v[8:11], v[28:29], a[72:73], v[8:11]
  v_mfma_f32_16x16x16_bf16 v[12:15], v[28:29], a[74:75], v[12:15]
  v_mfma_f32_16x16x16_bf16 v[8:11], v[30:31], a[76:77], v[8:11]
  v_mfma_f32_16x16x16_bf16 v[12:15], v[30:31], a[78:79], v[12:15]
  buffer_load_dwordx2 a[32:33], v145, s[32:35], s51 offen offset:0 nt
  buffer_load_dwordx2 a[34:35], v145, s[32:35], s51 offen offset:8 nt
  buffer_load_dwordx2 a[36:37], v145, s[32:35], s51 offen offset:1024 nt
  buffer_load_dwordx2 a[38:39], v145, s[32:35], s51 offen offset:1032 nt
  buffer_load_dwordx2 a[40:41], v145, s[32:35], s51 offen offset:2048 nt
  buffer_load_dwordx2 a[42:43], v145, s[32:35], s51 offen offset:2056 nt
  buffer_load_dwordx2 a[44:45], v145, s[32:35], s51 offen offset:3072 nt
  buffer_load_dwordx2 a[46:47], v145, s[32:35], s51 offen offset:3080 nt
  s_xor_b32 s51, s52, 0x941000
  v_mul_f32 v162, v162, v5
  v_cvt_pk_bf16_f32 v162, v162, v162
  v_and_b32_dpp v24, v161, v3 quad_perm:[0,0,0,0] row_mask:0xf bank_mask:0xf
  v_and_b32_dpp v25, v161, v4 quad_perm:[0,0,0,0] row_mask:0xf bank_mask:0xf
  v_and_b32_dpp v26, v161, v3 quad_perm:[1,1,1,1] row_mask:0xf bank_mask:0xf
  v_and_b32_dpp v27, v161, v4 quad_perm:[1,1,1,1] row_mask:0xf bank_mask:0xf
  v_and_b32_dpp v28, v161, v3 quad_perm:[2,2,2,2] row_mask:0xf bank_mask:0xf
  v_and_b32_dpp v29, v161, v4 quad_perm:[2,2,2,2] row_mask:0xf bank_mask:0xf
  v_and_b32_dpp v30, v161, v3 quad_perm:[3,3,3,3] row_mask:0xf bank_mask:0xf
  v_and_b32_dpp v31, v161, v4 quad_perm:[3,3,3,3] row_mask:0xf bank_mask:0xf
  v_mfma_f32_16x16x16_bf16 v[8:11], v[24:25], a[80:81], v[8:11]
  v_mfma_f32_16x16x16_bf16 v[12:15], v[24:25], a[82:83], v[12:15]
  v_mfma_f32_16x16x16_bf16 v[8:11], v[26:27], a[84:85], v[8:11]
  v_mfma_f32_16x16x16_bf16 v[12:15], v[26:27], a[86:87], v[12:15]
  v_mfma_f32_16x16x16_bf16 v[8:11], v[28:29], a[88:89], v[8:11]
  v_mfma_f32_16x16x16_bf16 v[12:15], v[28:29], a[90:91], v[12:15]
  v_mfma_f32_16x16x16_bf16 v[8:11], v[30:31], a[92:93], v[8:11]
  v_mfma_f32_16x16x16_bf16 v[12:15], v[30:31], a[94:95], v[12:15]
  s_cmp_ge_u32 s74, 128
  s_cbranch_scc1 L_nog
L_ychk:
  s_mov_b32 exec_hi, 0
  v_xor_b32 v44, s64, v44
  v_xor_b32 v45, s65, v45
  v_xor_b32 v46, s66, v46
  v_xor_b32 v47, s67, v47
  s_mov_b64 exec, -1
  v_xor_b32 v32, s64, v32
  v_xor_b32 v33, s65, v33
  v_xor_b32 v34, s66, v34
  v_xor_b32 v35, s67, v35
  v_xor_b32 v36, s64, v36
  v_xor_b32 v37, s65, v37
  v_xor_b32 v38, s66, v38
  v_xor_b32 v39, s67, v39
  v_xor_b32 v40, s64, v40
  v_xor_b32 v41, s65, v41
  v_xor_b32 v42, s66, v42
  v_xor_b32 v43, s67, v43
  v_or_b32 v7, v32, v33
  v_or3_b32 v7, v7, v34, v35
  v_or3_b32 v7, v7, v36, v37
  v_or3_b32 v7, v7, v38, v39
  v_or3_b32 v7, v7, v40, v41
  v_or3_b32 v7, v7, v42, v43
  v_or3_b32 v7, v7, v44, v45
  v_or3_b32 v7, v7, v46, v47
  v_and_b32 v7, v52, v7
  v_cmp_ne_u32 vcc, 0, v7
  s_cbranch_vccnz L_yretry
L_yok:
  v_pk_add_f32 v[32:33], v[32:33], v[36:37]
  v_pk_add_f32 v[34:35], v[34:35], v[38:39]
  v_pk_add_f32 v[40:41], v[40:41], v[44:45]
  v_pk_add_f32 v[42:43], v[42:43], v[46:47]
  v_pk_add_f32 v[32:33], v[32:33], v[40:41]
  v_pk_add_f32 v[34:35], v[34:35], v[42:43]
  s_nop 0
  v_add_f32_dpp v32, v32, v32 row_ror:8 row_mask:0xf bank_mask:0xf
  v_add_f32_dpp v33, v33, v33 row_ror:8 row_mask:0xf bank_mask:0xf
  v_add_f32_dpp v34, v34, v34 row_ror:8 row_mask:0xf bank_mask:0xf
  v_add_f32_dpp v35, v35, v35 row_ror:8 row_mask:0xf bank_mask:0xf
  v_mov_b32 v36, v32
  v_mov_b32 v37, v33
  v_mov_b32 v38, v34
  v_mov_b32 v39, v35
  v_permlane16_swap_b32 v32, v36
  v_permlane16_swap_b32 v33, v37
  v_permlane16_swap_b32 v34, v38
  v_permlane16_swap_b32 v35, v39
  v_pk_add_f32 v[32:33], v[32:33], v[36:37]
  v_pk_add_f32 v[34:35], v[34:35], v[38:39]
  v_mov_b32 v36, v32
  v_mov_b32 v37, v33
  v_mov_b32 v38, v34
  v_mov_b32 v39, v35
  v_permlane32_swap_b32 v32, v36
  v_permlane32_swap_b32 v33, v37
  v_permlane32_swap_b32 v34, v38
  v_permlane32_swap_b32 v35, v39
  v_pk_add_f32 v[32:33], v[32:33], v[36:37]
  v_pk_add_f32 v[34:35], v[34:35], v[38:39]
  v_cvt_pk_bf16_f32 v32, v32, v32
  v_cvt_pk_bf16_f32 v33, v33, v33
  v_cvt_pk_bf16_f32 v34, v34, v34
  v_cvt_pk_bf16_f32 v35, v35, v35
  v_and_b32 v32, s68, v32
  v_and_b32 v33, s68, v33
  v_and_b32 v34, s68, v34
  v_and_b32 v35, s68, v35
  v_mul_f32 v36, 0xbfb8aa3b, v32
  v_mul_f32 v37, 0xbfb8aa3b, v33
  v_mul_f32 v38, 0xbfb8aa3b, v34
  v_mul_f32 v39, 0xbfb8aa3b, v35
  v_exp_f32 v36, v36
  v_exp_f32 v37, v37
  v_exp_f32 v38, v38
  v_exp_f32 v39, v39
  v_add_f32 v36, 1.0, v36
  v_add_f32 v37, 1.0, v37
  v_add_f32 v38, 1.0, v38
  v_add_f32 v39, 1.0, v39
  v_rcp_f32 v36, v36
  v_rcp_f32 v37, v37
  v_rcp_f32 v38, v38
  v_rcp_f32 v39, v39
  v_mul_f32 v32, v32, v36
  v_mul_f32 v33, v33, v37
  v_mul_f32 v34, v34, v38
  v_mul_f32 v35, v35, v39
  v_cvt_pk_bf16_f32 v32, v32, v32
  v_cvt_pk_bf16_f32 v33, v33, v33
  v_cvt_pk_bf16_f32 v34, v34, v34
  v_cvt_pk_bf16_f32 v35, v35, v35
  s_and_b32 s60, s55, 0xffff
  s_lshr_b32 s61, s55, 16
  v_lshl_or_b32 v32, v32, 16, s60
  v_lshl_or_b32 v33, v33, 16, s61
  v_lshl_or_b32 v34, v34, 16, s60
  v_lshl_or_b32 v35, v35, 16, s61
  s_mul_i32 s56, s74, 1280
  s_add_u32 s56, s56, 229376
  s_mov_b64 exec, 0xff
  buffer_store_dwordx4 v[32:35], v2, s[40:43], s56 offen sc1
  s_mov_b64 exec, -1
L_nog:
  v_mul_f32 v163, v163, v5
  v_cvt_pk_bf16_f32 v163, v163, v163
  v_and_b32_dpp v24, v162, v3 quad_perm:[0,0,0,0] row_mask:0xf bank_mask:0xf
  v_and_b32_dpp v25, v162, v4 quad_perm:[0,0,0,0] row_mask:0xf bank_mask:0xf
  v_and_b32_dpp v26, v162, v3 quad_perm:[1,1,1,1] row_mask:0xf bank_mask:0xf
  v_and_b32_dpp v27, v162, v4 quad_perm:[1,1,1,1] row_mask:0xf bank_mask:0xf
  v_and_b32_dpp v28, v162, v3 quad_perm:[2,2,2,2] row_mask:0xf bank_mask:0xf
  v_and_b32_dpp v29, v162, v4 quad_perm:[2,2,2,2] row_mask:0xf bank_mask:0xf
  v_and_b32_dpp v30, v162, v3 quad_perm:[3,3,3,3] row_mask:0xf bank_mask:0xf
  v_and_b32_dpp v31, v162, v4 quad_perm:[3,3,3,3] row_mask:0xf bank_mask:0xf
  v_mfma_f32_16x16x16_bf16 v[8:11], v[24:25], a[96:97], v[8:11]
  v_mfma_f32_16x16x16_bf16 v[12:15], v[24:25], a[98:99], v[12:15]
  v_mfma_f32_16x16x16_bf16 v[8:11], v[26:27], a[100:101], v[8:11]
  v_mfma_f32_16x16x16_bf16 v[12:15], v[26:27], a[102:103], v[12:15]
  v_mfma_f32_16x16x16_bf16 v[8:11], v[28:29], a[104:105], v[8:11]
  v_mfma_f32_16x16x16_bf16 v[12:15], v[28:29], a[106:107], v[12:15]
  v_mfma_f32_16x16x16_bf16 v[8:11], v[30:31], a[108:109], v[8:11]
  v_mfma_f32_16x16x16_bf16 v[12:15], v[30:31], a[110:111], v[12:15]
  buffer_load_dwordx4 a[48:51], v145, s[32:35], s51 offen offset:0 nt
  buffer_load_dwordx4 a[52:55], v145, s[32:35], s51 offen offset:1024 nt
  buffer_load_dwordx4 a[56:59], v145, s[32:35], s51 offen offset:2048 nt
  buffer_load_dwordx4 a[60:63], v145, s[32:35], s51 offen offset:3072 nt
  s_xor_b32 s51, s52, 0x4d4000
  v_mul_f32 v164, v164, v5
  v_cvt_pk_bf16_f32 v164, v164, v164
  v_and_b32_dpp v24, v163, v3 quad_perm:[0,0,0,0] row_mask:0xf bank_mask:0xf
  v_and_b32_dpp v25, v163, v4 quad_perm:[0,0,0,0] row_mask:0xf bank_mask:0xf
  v_and_b32_dpp v26, v163, v3 quad_perm:[1,1,1,1] row_mask:0xf bank_mask:0xf
  v_and_b32_dpp v27, v163, v4 quad_perm:[1,1,1,1] row_mask:0xf bank_mask:0xf
  v_and_b32_dpp v28, v163, v3 quad_perm:[2,2,2,2] row_mask:0xf bank_mask:0xf
  v_and_b32_dpp v29, v163, v4 quad_perm:[2,2,2,2] row_mask:0xf bank_mask:0xf
  v_and_b32_dpp v30, v163, v3 quad_perm:[3,3,3,3] row_mask:0xf bank_mask:0xf
  v_and_b32_dpp v31, v163, v4 quad_perm:[3,3,3,3] row_mask:0xf bank_mask:0xf
  v_mfma_f32_16x16x16_bf16 v[8:11], v[24:25], a[112:113], v[8:11]
  v_mfma_f32_16x16x16_bf16 v[12:15], v[24:25], a[114:115], v[12:15]
  v_mfma_f32_16x16x16_bf16 v[8:11], v[26:27], a[116:117], v[8:11]
  v_mfma_f32_16x16x16_bf16 v[12:15], v[26:27], a[118:119], v[12:15]
  v_mfma_f32_16x16x16_bf16 v[8:11], v[28:29], a[120:121], v[8:11]
  v_mfma_f32_16x16x16_bf16 v[12:15], v[28:29], a[122:123], v[12:15]
  v_mfma_f32_16x16x16_bf16 v[8:11], v[30:31], a[124:125], v[8:11]
  v_mfma_f32_16x16x16_bf16 v[12:15], v[30:31], a[126:127], v[12:15]
  v_mul_f32 v165, v165, v5
  v_cvt_pk_bf16_f32 v165, v165, v165
  v_and_b32_dpp v24, v164, v3 quad_perm:[0,0,0,0] row_mask:0xf bank_mask:0xf
  v_and_b32_dpp v25, v164, v4 quad_perm:[0,0,0,0] row_mask:0xf bank_mask:0xf
  v_and_b32_dpp v26, v164, v3 quad_perm:[1,1,1,1] row_mask:0xf bank_mask:0xf
  v_and_b32_dpp v27, v164, v4 quad_perm:[1,1,1,1] row_mask:0xf bank_mask:0xf
  v_and_b32_dpp v28, v164, v3 quad_perm:[2,2,2,2] row_mask:0xf bank_mask:0xf
  v_and_b32_dpp v29, v164, v4 quad_perm:[2,2,2,2] row_mask:0xf bank_mask:0xf
  v_and_b32_dpp v30, v164, v3 quad_perm:[3,3,3,3] row_mask:0xf bank_mask:0xf
  v_and_b32_dpp v31, v164, v4 quad_perm:[3,3,3,3] row_mask:0xf bank_mask:0xf
  v_mfma_f32_16x16x16_bf16 v[8:11], v[24:25], a[128:129], v[8:11]
  v_mfma_f32_16x16x16_bf16 v[12:15], v[24:25], a[130:131], v[12:15]
  v_mfma_f32_16x16x16_bf16 v[8:11], v[26:27], a[132:133], v[8:11]
  v_mfma_f32_16x16x16_bf16 v[12:15], v[26:27], a[134:135], v[12:15]
  v_mfma_f32_16x16x16_bf16 v[8:11], v[28:29], a[136:137], v[8:11]
  v_mfma_f32_16x16x16_bf16 v[12:15], v[28:29], a[138:139], v[12:15]
  v_mfma_f32_16x16x16_bf16 v[8:11], v[30:31], a[140:141], v[8:11]
  v_mfma_f32_16x16x16_bf16 v[12:15], v[30:31], a[142:143], v[12:15]
  s_lshl_b32 s56, s49, 9
  s_add_u32 s56, s56, 196992
  s_cmp_lg_u32 s48, 2
  s_cbranch_scc1 L_noflag2
  s_lshl_b32 s57, s50, 2
  s_add_u32 s57, s57, s56
  v_mov_b32 v134, s55
  s_mov_b64 exec, 1
  buffer_store_dword v134, v2, s[40:43], s57 offen
  s_mov_b64 exec, -1
L_noflag2:
  v_and_b32 v135, 31, v0
  v_lshlrev_b32 v135, 2, v135
  buffer_load_dword v104, v135, s[40:43], s56 offen sc1
  buffer_load_dwordx2 a[64:65], v145, s[32:35], s51 offen offset:0 nt
  buffer_load_dwordx2 a[66:67], v145, s[32:35], s51 offen offset:8 nt
  buffer_load_dwordx2 a[68:69], v145, s[32:35], s51 offen offset:1024 nt
  buffer_load_dwordx2 a[70:71], v145, s[32:35], s51 offen offset:1032 nt
  buffer_load_dwordx2 a[72:73], v145, s[32:35], s51 offen offset:2048 nt
  buffer_load_dwordx2 a[74:75], v145, s[32:35], s51 offen offset:2056 nt
  buffer_load_dwordx2 a[76:77], v145, s[32:35], s51 offen offset:3072 nt
  buffer_load_dwordx2 a[78:79], v145, s[32:35], s51 offen offset:3080 nt
  s_xor_b32 s51, s52, 0x5d5000
  v_mul_f32 v166, v166, v5
  v_cvt_pk_bf16_f32 v166, v166, v166
  v_and_b32_dpp v24, v165, v3 quad_perm:[0,0,0,0] row_mask:0xf bank_mask:0xf
  v_and_b32_dpp v25, v165, v4 quad_perm:[0,0,0,0] row_mask:0xf bank_mask:0xf
  v_and_b32_dpp v26, v165, v3 quad_perm:[1,1,1,1] row_mask:0xf bank_mask:0xf
  v_and_b32_dpp v27, v165, v4 quad_perm:[1,1,1,1] row_mask:0xf bank_mask:0xf
  v_and_b32_dpp v28, v165, v3 quad_perm:[2,2,2,2] row_mask:0xf bank_mask:0xf
  v_and_b32_dpp v29, v165, v4 quad_perm:[2,2,2,2] row_mask:0xf bank_mask:0xf
  v_and_b32_dpp v30, v165, v3 quad_perm:[3,3,3,3] row_mask:0xf bank_mask:0xf
  v_and_b32_dpp v31, v165, v4 quad_perm:[3,3,3,3] row_mask:0xf bank_mask:0xf
  v_mfma_f32_16x16x16_bf16 v[8:11], v[24:25], a[144:145], v[8:11]
  v_mfma_f32_16x16x16_bf16 v[12:15], v[24:25], a[146:147], v[12:15]
  v_mfma_f32_16x16x16_bf16 v[8:11], v[26:27], a[148:149], v[8:11]
  v_mfma_f32_16x16x16_bf16 v[12:15], v[26:27], a[150:151], v[12:15]
  v_mfma_f32_16x16x16_bf16 v[8:11], v[28:29], a[152:153], v[8:11]
  v_mfma_f32_16x16x16_bf16 v[12:15], v[28:29], a[154:155], v[12:15]
  v_mfma_f32_16x16x16_bf16 v[8:11], v[30:31], a[156:157], v[8:11]
  v_mfma_f32_16x16x16_bf16 v[12:15], v[30:31], a[158:159], v[12:15]
  v_mul_f32 v167, v167, v5
  v_cvt_pk_bf16_f32 v167, v167, v167
  v_and_b32_dpp v24, v166, v3 quad_perm:[0,0,0,0] row_mask:0xf bank_mask:0xf
  v_and_b32_dpp v25, v166, v4 quad_perm:[0,0,0,0] row_mask:0xf bank_mask:0xf
  v_and_b32_dpp v26, v166, v3 quad_perm:[1,1,1,1] row_mask:0xf bank_mask:0xf
  v_and_b32_dpp v27, v166, v4 quad_perm:[1,1,1,1] row_mask:0xf bank_mask:0xf
  v_and_b32_dpp v28, v166, v3 quad_perm:[2,2,2,2] row_mask:0xf bank_mask:0xf
  v_and_b32_dpp v29, v166, v4 quad_perm:[2,2,2,2] row_mask:0xf bank_mask:0xf
  v_and_b32_dpp v30, v166, v3 quad_perm:[3,3,3,3] row_mask:0xf bank_mask:0xf
  v_and_b32_dpp v31, v166, v4 quad_perm:[3,3,3,3] row_mask:0xf bank_mask:0xf
  v_mfma_f32_16x16x16_bf16 v[8:11], v[24:25], a[160:161], v[8:11]
  v_mfma_f32_16x16x16_bf16 v[12:15], v[24:25], a[162:163], v[12:15]
  v_mfma_f32_16x16x16_bf16 v[8:11], v[26:27], a[164:165], v[8:11]
  v_mfma_f32_16x16x16_bf16 v[12:15], v[26:27], a[166:167], v[12:15]
  v_mfma_f32_16x16x16_bf16 v[8:11], v[28:29], a[168:169], v[8:11]
  v_mfma_f32_16x16x16_bf16 v[12:15], v[28:29], a[170:171], v[12:15]
  v_mfma_f32_16x16x16_bf16 v[8:11], v[30:31], a[172:173], v[8:11]
  v_mfma_f32_16x16x16_bf16 v[12:15], v[30:31], a[174:175], v[12:15]
  buffer_load_dwordx4 a[80:83], v145, s[32:35], s51 offen offset:0 nt
  buffer_load_dwordx4 a[84:87], v145, s[32:35], s51 offen offset:1024 nt
  buffer_load_dwordx4 a[88:91], v145, s[32:35], s51 offen offset:2048 nt
  buffer_load_dwordx4 a[92:95], v145, s[32:35], s51 offen offset:3072 nt
  s_xor_b32 s51, s52, 0xcc4000
  v_mul_f32 v168, v168, v5
  v_cvt_pk_bf16_f32 v168, v168, v168
  v_and_b32_dpp v24, v167, v3 quad_perm:[0,0,0,0] row_mask:0xf bank_mask:0xf
  v_and_b32_dpp v25, v167, v4 quad_perm:[0,0,0,0] row_mask:0xf bank_mask:0xf
  v_and_b32_dpp v26, v167, v3 quad_perm:[1,1,1,1] row_mask:0xf bank_mask:0xf
  v_and_b32_dpp v27, v167, v4 quad_perm:[1,1,1,1] row_mask:0xf bank_mask:0xf
  v_and_b32_dpp v28, v167, v3 quad_perm:[2,2,2,2] row_mask:0xf bank_mask:0xf
  v_and_b32_dpp v29, v167, v4 quad_perm:[2,2,2,2] row_mask:0xf bank_mask:0xf
  v_and_b32_dpp v30, v167, v3 quad_perm:[3,3,3,3] row_mask:0xf bank_mask:0xf
  v_and_b32_dpp v31, v167, v4 quad_perm:[3,3,3,3] row_mask:0xf bank_mask:0xf
  s_waitcnt vmcnt(53)
  v_mfma_f32_16x16x16_bf16 v[8:11], v[24:25], a[176:177], v[8:11]
  v_mfma_f32_16x16x16_bf16 v[12:15], v[24:25], a[178:179], v[12:15]
  v_mfma_f32_16x16x16_bf16 v[8:11], v[26:27], a[180:181], v[8:11]
  v_mfma_f32_16x16x16_bf16 v[12:15], v[26:27], a[182:183], v[12:15]
  v_mfma_f32_16x16x16_bf16 v[8:11], v[28:29], a[184:185], v[8:11]
  v_mfma_f32_16x16x16_bf16 v[12:15], v[28:29], a[186:187], v[12:15]
  v_mfma_f32_16x16x16_bf16 v[8:11], v[30:31], a[188:189], v[8:11]
  v_mfma_f32_16x16x16_bf16 v[12:15], v[30:31], a[190:191], v[12:15]
  v_mul_f32 v169, v169, v5
  v_cvt_pk_bf16_f32 v169, v169, v169
  v_and_b32_dpp v24, v168, v3 quad_perm:[0,0,0,0] row_mask:0xf bank_mask:0xf
  v_and_b32_dpp v25, v168, v4 quad_perm:[0,0,0,0] row_mask:0xf bank_mask:0xf
  v_and_b32_dpp v26, v168, v3 quad_perm:[1,1,1,1] row_mask:0xf bank_mask:0xf
  v_and_b32_dpp v27, v168, v4 quad_perm:[1,1,1,1] row_mask:0xf bank_mask:0xf
  v_and_b32_dpp v28, v168, v3 quad_perm:[2,2,2,2] row_mask:0xf bank_mask:0xf
  v_and_b32_dpp v29, v168, v4 quad_perm:[2,2,2,2] row_mask:0xf bank_mask:0xf
  v_and_b32_dpp v30, v168, v3 quad_perm:[3,3,3,3] row_mask:0xf bank_mask:0xf
  v_and_b32_dpp v31, v168, v4 quad_perm:[3,3,3,3] row_mask:0xf bank_mask:0xf
  s_waitcnt vmcnt(49)
  v_mfma_f32_16x16x16_bf16 v[8:11], v[24:25], a[192:193], v[8:11]
  v_mfma_f32_16x16x16_bf16 v[12:15], v[24:25], a[194:195], v[12:15]
  v_mfma_f32_16x16x16_bf16 v[8:11], v[26:27], a[196:197], v[8:11]
  v_mfma_f32_16x16x16_bf16 v[12:15], v[26:27], a[198:199], v[12:15]
  v_mfma_f32_16x16x16_bf16 v[8:11], v[28:29], a[200:201], v[8:11]
  v_mfma_f32_16x16x16_bf16 v[12:15], v[28:29], a[202:203], v[12:15]
  v_mfma_f32_16x16x16_bf16 v[8:11], v[30:31], a[204:205], v[8:11]
  v_mfma_f32_16x16x16_bf16 v[12:15], v[30:31], a[206:207], v[12:15]
  buffer_load_dwordx2 a[96:97], v145, s[32:35], s51 offen offset:0 nt
  buffer_load_dwordx2 a[98:99], v145, s[32:35], s51 offen offset:8 nt
  buffer_load_dwordx2 a[100:101], v145, s[32:35], s51 offen offset:1024 nt
  buffer_load_dwordx2 a[102:103], v145, s[32:35], s51 offen offset:1032 nt
  buffer_load_dwordx2 a[104:105], v145, s[32:35], s51 offen offset:2048 nt
  buffer_load_dwordx2 a[106:107], v145, s[32:35], s51 offen offset:2056 nt
  buffer_load_dwordx2 a[108:109], v145, s[32:35], s51 offen offset:3072 nt
  buffer_load_dwordx2 a[110:111], v145, s[32:35], s51 offen offset:3080 nt
  s_xor_b32 s51, s52, 0xdc5000
  v_mul_f32 v170, v170, v5
  v_cvt_pk_bf16_f32 v170, v170, v170
  v_and_b32_dpp v24, v169, v3 quad_perm:[0,0,0,0] row_mask:0xf bank_mask:0xf
  v_and_b32_dpp v25, v169, v4 quad_perm:[0,0,0,0] row_mask:0xf bank_mask:0xf
  v_and_b32_dpp v26, v169, v3 quad_perm:[1,1,1,1] row_mask:0xf bank_mask:0xf
  v_and_b32_dpp v27, v169, v4 quad_perm:[1,1,1,1] row_mask:0xf bank_mask:0xf
  v_and_b32_dpp v28, v169, v3 quad_perm:[2,2,2,2] row_mask:0xf bank_mask:0xf
  v_and_b32_dpp v29, v169, v4 quad_perm:[2,2,2,2] row_mask:0xf bank_mask:0xf
  v_and_b32_dpp v30, v169, v3 quad_perm:[3,3,3,3] row_mask:0xf bank_mask:0xf
  v_and_b32_dpp v31, v169, v4 quad_perm:[3,3,3,3] row_mask:0xf bank_mask:0xf
  s_waitcnt vmcnt(53)
  v_mfma_f32_16x16x16_bf16 v[8:11], v[24:25], a[208:209], v[8:11]
  v_mfma_f32_16x16x16_bf16 v[12:15], v[24:25], a[210:211], v[12:15]
  v_mfma_f32_16x16x16_bf16 v[8:11], v[26:27], a[212:213], v[8:11]
  v_mfma_f32_16x16x16_bf16 v[12:15], v[26:27], a[214:215], v[12:15]
  v_mfma_f32_16x16x16_bf16 v[8:11], v[28:29], a[216:217], v[8:11]
  v_mfma_f32_16x16x16_bf16 v[12:15], v[28:29], a[218:219], v[12:15]
  v_mfma_f32_16x16x16_bf16 v[8:11], v[30:31], a[220:221], v[8:11]
  v_mfma_f32_16x16x16_bf16 v[12:15], v[30:31], a[222:223], v[12:15]
  v_mul_f32 v171, v171, v5
  v_cvt_pk_bf16_f32 v171, v171, v171
  v_and_b32_dpp v24, v170, v3 quad_perm:[0,0,0,0] row_mask:0xf bank_mask:0xf
  v_and_b32_dpp v25, v170, v4 quad_perm:[0,0,0,0] row_mask:0xf bank_mask:0xf
  v_and_b32_dpp v26, v170, v3 quad_perm:[1,1,1,1] row_mask:0xf bank_mask:0xf
  v_and_b32_dpp v27, v170, v4 quad_perm:[1,1,1,1] row_mask:0xf bank_mask:0xf
  v_and_b32_dpp v28, v170, v3 quad_perm:[2,2,2,2] row_mask:0xf bank_mask:0xf
  v_and_b32_dpp v29, v170, v4 quad_perm:[2,2,2,2] row_mask:0xf bank_mask:0xf
  v_and_b32_dpp v30, v170, v3 quad_perm:[3,3,3,3] row_mask:0xf bank_mask:0xf
  v_and_b32_dpp v31, v170, v4 quad_perm:[3,3,3,3] row_mask:0xf bank_mask:0xf
  s_waitcnt vmcnt(49)
  v_mfma_f32_16x16x16_bf16 v[8:11], v[24:25], a[224:225], v[8:11]
  v_mfma_f32_16x16x16_bf16 v[12:15], v[24:25], a[226:227], v[12:15]
  v_mfma_f32_16x16x16_bf16 v[8:11], v[26:27], a[228:229], v[8:11]
  v_mfma_f32_16x16x16_bf16 v[12:15], v[26:27], a[230:231], v[12:15]
  v_mfma_f32_16x16x16_bf16 v[8:11], v[28:29], a[232:233], v[8:11]
  v_mfma_f32_16x16x16_bf16 v[12:15], v[28:29], a[234:235], v[12:15]
  v_mfma_f32_16x16x16_bf16 v[8:11], v[30:31], a[236:237], v[8:11]
  v_mfma_f32_16x16x16_bf16 v[12:15], v[30:31], a[238:239], v[12:15]
  buffer_load_dwordx4 a[112:115], v145, s[32:35], s51 offen offset:0 nt
  buffer_load_dwordx4 a[116:119], v145, s[32:35], s51 offen offset:1024 nt
  buffer_load_dwordx4 a[120:123], v145, s[32:35], s51 offen offset:2048 nt
  buffer_load_dwordx4 a[124:127], v145, s[32:35], s51 offen offset:3072 nt
  s_xor_b32 s51, s52, 0x70000
  v_mul_f32 v172, v172, v5
  v_cvt_pk_bf16_f32 v172, v172, v172
  v_and_b32_dpp v24, v171, v3 quad_perm:[0,0,0,0] row_mask:0xf bank_mask:0xf
  v_and_b32_dpp v25, v171, v4 quad_perm:[0,0,0,0] row_mask:0xf bank_mask:0xf
  v_and_b32_dpp v26, v171, v3 quad_perm:[1,1,1,1] row_mask:0xf bank_mask:0xf
  v_and_b32_dpp v27, v171, v4 quad_perm:[1,1,1,1] row_mask:0xf bank_mask:0xf
  v_and_b32_dpp v28, v171, v3 quad_perm:[2,2,2,2] row_mask:0xf bank_mask:0xf
  v_and_b32_dpp v29, v171, v4 quad_perm:[2,2,2,2] row_mask:0xf bank_mask:0xf
  v_and_b32_dpp v30, v171, v3 quad_perm:[3,3,3,3] row_mask:0xf bank_mask:0xf
  v_and_b32_dpp v31, v171, v4 quad_perm:[3,3,3,3] row_mask:0xf bank_mask:0xf
  s_waitcnt vmcnt(49)
  v_mfma_f32_16x16x16_bf16 v[8:11], v[24:25], a[240:241], v[8:11]
  v_mfma_f32_16x16x16_bf16 v[12:15], v[24:25], a[242:243], v[12:15]
  v_mfma_f32_16x16x16_bf16 v[8:11], v[26:27], a[244:245], v[8:11]
  v_mfma_f32_16x16x16_bf16 v[12:15], v[26:27], a[246:247], v[12:15]
  v_mfma_f32_16x16x16_bf16 v[8:11], v[28:29], a[248:249], v[8:11]
  v_mfma_f32_16x16x16_bf16 v[12:15], v[28:29], a[250:251], v[12:15]
  v_mfma_f32_16x16x16_bf16 v[8:11], v[30:31], a[252:253], v[8:11]
  v_mfma_f32_16x16x16_bf16 v[12:15], v[30:31], a[254:255], v[12:15]
  v_mul_f32 v173, v173, v5
  v_cvt_pk_bf16_f32 v173, v173, v173
  v_and_b32_dpp v24, v172, v3 quad_perm:[0,0,0,0] row_mask:0xf bank_mask:0xf
  v_and_b32_dpp v25, v172, v4 quad_perm:[0,0,0,0] row_mask:0xf bank_mask:0xf
  v_and_b32_dpp v26, v172, v3 quad_perm:[1,1,1,1] row_mask:0xf bank_mask:0xf
  v_and_b32_dpp v27, v172, v4 quad_perm:[1,1,1,1] row_mask:0xf bank_mask:0xf
  v_and_b32_dpp v28, v172, v3 quad_perm:[2,2,2,2] row_mask:0xf bank_mask:0xf
  v_and_b32_dpp v29, v172, v4 quad_perm:[2,2,2,2] row_mask:0xf bank_mask:0xf
  v_and_b32_dpp v30, v172, v3 quad_perm:[3,3,3,3] row_mask:0xf bank_mask:0xf
  v_and_b32_dpp v31, v172, v4 quad_perm:[3,3,3,3] row_mask:0xf bank_mask:0xf
  s_waitcnt vmcnt(41)
  v_mfma_f32_16x16x16_bf16 v[8:11], v[24:25], a[0:1], v[8:11]
  v_mfma_f32_16x16x16_bf16 v[12:15], v[24:25], a[2:3], v[12:15]
  v_mfma_f32_16x16x16_bf16 v[8:11], v[26:27], a[4:5], v[8:11]
  v_mfma_f32_16x16x16_bf16 v[12:15], v[26:27], a[6:7], v[12:15]
  v_mfma_f32_16x16x16_bf16 v[8:11], v[28:29], a[8:9], v[8:11]
  v_mfma_f32_16x16x16_bf16 v[12:15], v[28:29], a[10:11], v[12:15]
  v_mfma_f32_16x16x16_bf16 v[8:11], v[30:31], a[12:13], v[8:11]
  v_mfma_f32_16x16x16_bf16 v[12:15], v[30:31], a[14:15], v[12:15]
  s_waitcnt vmcnt(24)
  v_cmp_eq_u32 vcc, s55, v104
  s_bcnt1_i32_b32 s56, vcc_lo
  s_mov_b32 s14, 1
  s_cmp_gt_u32 s56, 3
  s_addc_u32 s14, s14, 0
  s_cmp_gt_u32 s56, 13
  s_addc_u32 s14, s14, 0
  s_cmp_gt_u32 s56, 24
  s_addc_u32 s14, s14, 0
  s_cmp_gt_u32 s56, 29
  s_addc_u32 s14, s14, 0
  s_cmp_gt_u32 s56, 30
  s_addc_u32 s14, s14, 0
  s_cmp_le_i32 s14, 5
  s_cbranch_scc1 L_vs56
  buffer_load_dwordx4 a[128:131], v145, s[32:35], s51 offen offset:0 nt
  buffer_load_dwordx4 a[132:135], v145, s[32:35], s51 offen offset:1024 nt
  buffer_load_dwordx4 a[136:139], v145, s[32:35], s51 offen offset:2048 nt
  buffer_load_dwordx4 a[140:143], v145, s[32:35], s51 offen offset:3072 nt
L_vj56:
  s_xor_b32 s51, s52, 0x171000
  v_mul_f32 v174, v174, v5
  v_cvt_pk_bf16_f32 v174, v174, v174
  v_and_b32_dpp v24, v173, v3 quad_perm:[0,0,0,0] row_mask:0xf bank_mask:0xf
  v_and_b32_dpp v25, v173, v4 quad_perm:[0,0,0,0] row_mask:0xf bank_mask:0xf
  v_and_b32_dpp v26, v173, v3 quad_perm:[1,1,1,1] row_mask:0xf bank_mask:0xf
  v_and_b32_dpp v27, v173, v4 quad_perm:[1,1,1,1] row_mask:0xf bank_mask:0xf
  v_and_b32_dpp v28, v173, v3 quad_perm:[2,2,2,2] row_mask:0xf bank_mask:0xf
  v_and_b32_dpp v29, v173, v4 quad_perm:[2,2,2,2] row_mask:0xf bank_mask:0xf
  v_and_b32_dpp v30, v173, v3 quad_perm:[3,3,3,3] row_mask:0xf bank_mask:0xf
  v_and_b32_dpp v31, v173, v4 quad_perm:[3,3,3,3] row_mask:0xf bank_mask:0xf
  v_mfma_f32_16x16x16_bf16 v[8:11], v[24:25], a[16:17], v[8:11]
  v_mfma_f32_16x16x16_bf16 v[12:15], v[24:25], a[18:19], v[12:15]
  v_mfma_f32_16x16x16_bf16 v[8:11], v[26:27], a[20:21], v[8:11]
  v_mfma_f32_16x16x16_bf16 v[12:15], v[26:27], a[22:23], v[12:15]
  v_mfma_f32_16x16x16_bf16 v[8:11], v[28:29], a[24:25], v[8:11]
  v_mfma_f32_16x16x16_bf16 v[12:15], v[28:29], a[26:27], v[12:15]
  v_mfma_f32_16x16x16_bf16 v[8:11], v[30:31], a[28:29], v[8:11]
  v_mfma_f32_16x16x16_bf16 v[12:15], v[30:31], a[30:31], v[12:15]
  v_mul_f32 v175, v175, v5
  v_cvt_pk_bf16_f32 v175, v175, v175
  v_and_b32_dpp v24, v174, v3 quad_perm:[0,0,0,0] row_mask:0xf bank_mask:0xf
  v_and_b32_dpp v25, v174, v4 quad_perm:[0,0,0,0] row_mask:0xf bank_mask:0xf
  v_and_b32_dpp v26, v174, v3 quad_perm:[1,1,1,1] row_mask:0xf bank_mask:0xf
  v_and_b32_dpp v27, v174, v4 quad_perm:[1,1,1,1] row_mask:0xf bank_mask:0xf
  v_and_b32_dpp v28, v174, v3 quad_perm:[2,2,2,2] row_mask:0xf bank_mask:0xf
  v_and_b32_dpp v29, v174, v4 quad_perm:[2,2,2,2] row_mask:0xf bank_mask:0xf
  v_and_b32_dpp v30, v174, v3 quad_perm:[3,3,3,3] row_mask:0xf bank_mask:0xf
  v_and_b32_dpp v31, v174, v4 quad_perm:[3,3,3,3] row_mask:0xf bank_mask:0xf
  v_mfma_f32_16x16x16_bf16 v[8:11], v[24:25], a[32:33], v[8:11]
  v_mfma_f32_16x16x16_bf16 v[12:15], v[24:25], a[34:35], v[12:15]
  v_mfma_f32_16x16x16_bf16 v[8:11], v[26:27], a[36:37], v[8:11]
  v_mfma_f32_16x16x16_bf16 v[12:15], v[26:27], a[38:39], v[12:15]
  v_mfma_f32_16x16x16_bf16 v[8:11], v[28:29], a[40:41], v[8:11]
  v_mfma_f32_16x16x16_bf16 v[12:15], v[28:29], a[42:43], v[12:15]
  v_mfma_f32_16x16x16_bf16 v[8:11], v[30:31], a[44:45], v[8:11]
  v_mfma_f32_16x16x16_bf16 v[12:15], v[30:31], a[46:47], v[12:15]
  s_cmp_le_i32 s14, 0
  s_cbranch_scc1 L_vs57
  buffer_load_dwordx4 a[144:147], v145, s[32:35], s51 offen offset:0 nt
  buffer_load_dwordx4 a[148:151], v145, s[32:35], s51 offen offset:1024 nt
  buffer_load_dwordx4 a[152:155], v145, s[32:35], s51 offen offset:2048 nt
  buffer_load_dwordx4 a[156:159], v145, s[32:35], s51 offen offset:3072 nt
L_vj57:
  s_xor_b32 s51, s52, 0x860000
  v_mul_f32 v176, v176, v5
  v_cvt_pk_bf16_f32 v176, v176, v176
  v_and_b32_dpp v24, v175, v3 quad_perm:[0,0,0,0] row_mask:0xf bank_mask:0xf
  v_and_b32_dpp v25, v175, v4 quad_perm:[0,0,0,0] row_mask:0xf bank_mask:0xf
  v_and_b32_dpp v26, v175, v3 quad_perm:[1,1,1,1] row_mask:0xf bank_mask:0xf
  v_and_b32_dpp v27, v175, v4 quad_perm:[1,1,1,1] row_mask:0xf bank_mask:0xf
  v_and_b32_dpp v28, v175, v3 quad_perm:[2,2,2,2] row_mask:0xf bank_mask:0xf
  v_and_b32_dpp v29, v175, v4 quad_perm:[2,2,2,2] row_mask:0xf bank_mask:0xf
  v_and_b32_dpp v30, v175, v3 quad_perm:[3,3,3,3] row_mask:0xf bank_mask:0xf
  v_and_b32_dpp v31, v175, v4 quad_perm:[3,3,3,3] row_mask:0xf bank_mask:0xf
  v_mfma_f32_16x16x16_bf16 v[8:11], v[24:25], a[48:49], v[8:11]
  v_mfma_f32_16x16x16_bf16 v[12:15], v[24:25], a[50:51], v[12:15]
  v_mfma_f32_16x16x16_bf16 v[8:11], v[26:27], a[52:53], v[8:11]
  v_mfma_f32_16x16x16_bf16 v[12:15], v[26:27], a[54:55], v[12:15]
  v_mfma_f32_16x16x16_bf16 v[8:11], v[28:29], a[56:57], v[8:11]
  v_mfma_f32_16x16x16_bf16 v[12:15], v[28:29], a[58:59], v[12:15]
  v_mfma_f32_16x16x16_bf16 v[8:11], v[30:31], a[60:61], v[8:11]
  v_mfma_f32_16x16x16_bf16 v[12:15], v[30:31], a[62:63], v[12:15]
  s_barrier
  s_cmp_le_i32 s14, 4
  s_cbranch_scc1 L_vs58
  buffer_load_dwordx4 a[160:163], v145, s[32:35], s51 offen offset:0 nt
  buffer_load_dwordx4 a[164:167], v145, s[32:35], s51 offen offset:1024 nt
  buffer_load_dwordx4 a[168:171], v145, s[32:35], s51 offen offset:2048 nt
  buffer_load_dwordx4 a[172:175], v145, s[32:35], s51 offen offset:3072 nt
L_vj58:
  s_xor_b32 s51, s52, 0x961000
  v_mul_f32 v177, v177, v5
  v_cvt_pk_bf16_f32 v177, v177, v177
  v_and_b32_dpp v24, v176, v3 quad_perm:[0,0,0,0] row_mask:0xf bank_mask:0xf
  v_and_b32_dpp v25, v176, v4 quad_perm:[0,0,0,0] row_mask:0xf bank_mask:0xf
  v_and_b32_dpp v26, v176, v3 quad_perm:[1,1,1,1] row_mask:0xf bank_mask:0xf
  v_and_b32_dpp v27, v176, v4 quad_perm:[1,1,1,1] row_mask:0xf bank_mask:0xf
  v_and_b32_dpp v28, v176, v3 quad_perm:[2,2,2,2] row_mask:0xf bank_mask:0xf
  v_and_b32_dpp v29, v176, v4 quad_perm:[2,2,2,2] row_mask:0xf bank_mask:0xf
  v_and_b32_dpp v30, v176, v3 quad_perm:[3,3,3,3] row_mask:0xf bank_mask:0xf
  v_and_b32_dpp v31, v176, v4 quad_perm:[3,3,3,3] row_mask:0xf bank_mask:0xf
  s_waitcnt vmcnt(28)
  v_mfma_f32_16x16x16_bf16 v[8:11], v[24:25], a[64:65], v[8:11]
  v_mfma_f32_16x16x16_bf16 v[12:15], v[24:25], a[66:67], v[12:15]
  v_mfma_f32_16x16x16_bf16 v[8:11], v[26:27], a[68:69], v[8:11]
  v_mfma_f32_16x16x16_bf16 v[12:15], v[26:27], a[70:71], v[12:15]
  v_mfma_f32_16x16x16_bf16 v[8:11], v[28:29], a[72:73], v[8:11]
  v_mfma_f32_16x16x16_bf16 v[12:15], v[28:29], a[74:75], v[12:15]
  v_mfma_f32_16x16x16_bf16 v[8:11], v[30:31], a[76:77], v[8:11]
  v_mfma_f32_16x16x16_bf16 v[12:15], v[30:31], a[78:79], v[12:15]
  s_cmp_le_i32 s14, 1
  s_cbranch_scc1 L_vs59
  buffer_load_dwordx4 a[176:179], v145, s[32:35], s51 offen offset:0 nt
  buffer_load_dwordx4 a[180:183], v145, s[32:35], s51 offen offset:1024 nt
  buffer_load_dwordx4 a[184:187], v145, s[32:35], s51 offen offset:2048 nt
  buffer_load_dwordx4 a[188:191], v145, s[32:35], s51 offen offset:3072 nt
L_vj59:
  s_xor_b32 s51, s52, 0x4f4000
  v_mul_f32 v178, v178, v5
  v_cvt_pk_bf16_f32 v178, v178, v178
  v_and_b32_dpp v24, v177, v3 quad_perm:[0,0,0,0] row_mask:0xf bank_mask:0xf
  v_and_b32_dpp v25, v177, v4 quad_perm:[0,0,0,0] row_mask:0xf bank_mask:0xf
  v_and_b32_dpp v26, v177, v3 quad_perm:[1,1,1,1] row_mask:0xf bank_mask:0xf
  v_and_b32_dpp v27, v177, v4 quad_perm:[1,1,1,1] row_mask:0xf bank_mask:0xf
  v_and_b32_dpp v28, v177, v3 quad_perm:[2,2,2,2] row_mask:0xf bank_mask:0xf
  v_and_b32_dpp v29, v177, v4 quad_perm:[2,2,2,2] row_mask:0xf bank_mask:0xf
  v_and_b32_dpp v30, v177, v3 quad_perm:[3,3,3,3] row_mask:0xf bank_mask:0xf
  v_and_b32_dpp v31, v177, v4 quad_perm:[3,3,3,3] row_mask:0xf bank_mask:0xf
  s_waitcnt vmcnt(28)
  v_mfma_f32_16x16x16_bf16 v[8:11], v[24:25], a[80:81], v[8:11]
  v_mfma_f32_16x16x16_bf16 v[12:15], v[24:25], a[82:83], v[12:15]
  v_mfma_f32_16x16x16_bf16 v[8:11], v[26:27], a[84:85], v[8:11]
  v_mfma_f32_16x16x16_bf16 v[12:15], v[26:27], a[86:87], v[12:15]
  v_mfma_f32_16x16x16_bf16 v[8:11], v[28:29], a[88:89], v[8:11]
  v_mfma_f32_16x16x16_bf16 v[12:15], v[28:29], a[90:91], v[12:15]
  v_mfma_f32_16x16x16_bf16 v[8:11], v[30:31], a[92:93], v[8:11]
  v_mfma_f32_16x16x16_bf16 v[12:15], v[30:31], a[94:95], v[12:15]
  s_cmp_le_i32 s14, 3
  s_cbranch_scc1 L_vs60
  buffer_load_dwordx4 a[192:195], v145, s[32:35], s51 offen offset:0 nt
  buffer_load_dwordx4 a[196:199], v145, s[32:35], s51 offen offset:1024 nt
  buffer_load_dwordx4 a[200:203], v145, s[32:35], s51 offen offset:2048 nt
  buffer_load_dwordx4 a[204:207], v145, s[32:35], s51 offen offset:3072 nt
L_vj60:
  s_xor_b32 s51, s52, 0x5f5000
  v_mul_f32 v179, v179, v5
  v_cvt_pk_bf16_f32 v179, v179, v179
  v_and_b32_dpp v24, v178, v3 quad_perm:[0,0,0,0] row_mask:0xf bank_mask:0xf
  v_and_b32_dpp v25, v178, v4 quad_perm:[0,0,0,0] row_mask:0xf bank_mask:0xf
  v_and_b32_dpp v26, v178, v3 quad_perm:[1,1,1,1] row_mask:0xf bank_mask:0xf
  v_and_b32_dpp v27, v178, v4 quad_perm:[1,1,1,1] row_mask:0xf bank_mask:0xf
  v_and_b32_dpp v28, v178, v3 quad_perm:[2,2,2,2] row_mask:0xf bank_mask:0xf
  v_and_b32_dpp v29, v178, v4 quad_perm:[2,2,2,2] row_mask:0xf bank_mask:0xf
  v_and_b32_dpp v30, v178, v3 quad_perm:[3,3,3,3] row_mask:0xf bank_mask:0xf
  v_and_b32_dpp v31, v178, v4 quad_perm:[3,3,3,3] row_mask:0xf bank_mask:0xf
  s_waitcnt vmcnt(24)
  v_mfma_f32_16x16x16_bf16 v[8:11], v[24:25], a[96:97], v[8:11]
  v_mfma_f32_16x16x16_bf16 v[12:15], v[24:25], a[98:99], v[12:15]
  v_mfma_f32_16x16x16_bf16 v[8:11], v[26:27], a[100:101], v[8:11]
  v_mfma_f32_16x16x16_bf16 v[12:15], v[26:27], a[102:103], v[12:15]
  v_mfma_f32_16x16x16_bf16 v[8:11], v[28:29], a[104:105], v[8:11]
  v_mfma_f32_16x16x16_bf16 v[12:15], v[28:29], a[106:107], v[12:15]
  v_mfma_f32_16x16x16_bf16 v[8:11], v[30:31], a[108:109], v[8:11]
  v_mfma_f32_16x16x16_bf16 v[12:15], v[30:31], a[110:111], v[12:15]
  s_cmp_le_i32 s14, 2
  s_cbranch_scc1 L_vs61
  buffer_load_dwordx4 a[208:211], v145, s[32:35], s51 offen offset:0 nt
  buffer_load_dwordx4 a[212:215], v145, s[32:35], s51 offen offset:1024 nt
  buffer_load_dwordx4 a[216:219], v145, s[32:35], s51 offen offset:2048 nt
  buffer_load_dwordx4 a[220:223], v145, s[32:35], s51 offen offset:3072 nt
L_vj61:
  s_xor_b32 s51, s52, 0xce4000
  v_mul_f32 v180, v180, v5
  v_cvt_pk_bf16_f32 v180, v180, v180
  v_and_b32_dpp v24, v179, v3 quad_perm:[0,0,0,0] row_mask:0xf bank_mask:0xf
  v_and_b32_dpp v25, v179, v4 quad_perm:[0,0,0,0] row_mask:0xf bank_mask:0xf
  v_and_b32_dpp v26, v179, v3 quad_perm:[1,1,1,1] row_mask:0xf bank_mask:0xf
  v_and_b32_dpp v27, v179, v4 quad_perm:[1,1,1,1] row_mask:0xf bank_mask:0xf
  v_and_b32_dpp v28, v179, v3 quad_perm:[2,2,2,2] row_mask:0xf bank_mask:0xf
  v_and_b32_dpp v29, v179, v4 quad_perm:[2,2,2,2] row_mask:0xf bank_mask:0xf
  v_and_b32_dpp v30, v179, v3 quad_perm:[3,3,3,3] row_mask:0xf bank_mask:0xf
  v_and_b32_dpp v31, v179, v4 quad_perm:[3,3,3,3] row_mask:0xf bank_mask:0xf
  s_waitcnt vmcnt(24)
  v_mfma_f32_16x16x16_bf16 v[8:11], v[24:25], a[112:113], v[8:11]
  v_mfma_f32_16x16x16_bf16 v[12:15], v[24:25], a[114:115], v[12:15]
  v_mfma_f32_16x16x16_bf16 v[8:11], v[26:27], a[116:117], v[8:11]
  v_mfma_f32_16x16x16_bf16 v[12:15], v[26:27], a[118:119], v[12:15]
  v_mfma_f32_16x16x16_bf16 v[8:11], v[28:29], a[120:121], v[8:11]
  v_mfma_f32_16x16x16_bf16 v[12:15], v[28:29], a[122:123], v[12:15]
  v_mfma_f32_16x16x16_bf16 v[8:11], v[30:31], a[124:125], v[8:11]
  v_mfma_f32_16x16x16_bf16 v[12:15], v[30:31], a[126:127], v[12:15]
  buffer_load_dwordx2 a[224:225], v145, s[32:35], s51 offen offset:0 nt
  buffer_load_dwordx2 a[226:227], v145, s[32:35], s51 offen offset:8 nt
  buffer_load_dwordx2 a[228:229], v145, s[32:35], s51 offen offset:1024 nt
  buffer_load_dwordx2 a[230:231], v145, s[32:35], s51 offen offset:1032 nt
  buffer_load_dwordx2 a[232:233], v145, s[32:35], s51 offen offset:2048 nt
  buffer_load_dwordx2 a[234:235], v145, s[32:35], s51 offen offset:2056 nt
  buffer_load_dwordx2 a[236:237], v145, s[32:35], s51 offen offset:3072 nt
  buffer_load_dwordx2 a[238:239], v145, s[32:35], s51 offen offset:3080 nt
  s_xor_b32 s51, s52, 0xde5000
  v_mul_f32 v181, v181, v5
  v_cvt_pk_bf16_f32 v181, v181, v181
  v_and_b32_dpp v24, v180, v3 quad_perm:[0,0,0,0] row_mask:0xf bank_mask:0xf
  v_and_b32_dpp v25, v180, v4 quad_perm:[0,0,0,0] row_mask:0xf bank_mask:0xf
  v_and_b32_dpp v26, v180, v3 quad_perm:[1,1,1,1] row_mask:0xf bank_mask:0xf
  v_and_b32_dpp v27, v180, v4 quad_perm:[1,1,1,1] row_mask:0xf bank_mask:0xf
  v_and_b32_dpp v28, v180, v3 quad_perm:[2,2,2,2] row_mask:0xf bank_mask:0xf
  v_and_b32_dpp v29, v180, v4 quad_perm:[2,2,2,2] row_mask:0xf bank_mask:0xf
  v_and_b32_dpp v30, v180, v3 quad_perm:[3,3,3,3] row_mask:0xf bank_mask:0xf
  v_and_b32_dpp v31, v180, v4 quad_perm:[3,3,3,3] row_mask:0xf bank_mask:0xf
  s_waitcnt vmcnt(28)
  v_mfma_f32_16x16x16_bf16 v[8:11], v[24:25], a[128:129], v[8:11]
  v_mfma_f32_16x16x16_bf16 v[12:15], v[24:25], a[130:131], v[12:15]
  v_mfma_f32_16x16x16_bf16 v[8:11], v[26:27], a[132:133], v[8:11]
  v_mfma_f32_16x16x16_bf16 v[12:15], v[26:27], a[134:135], v[12:15]
  v_mfma_f32_16x16x16_bf16 v[8:11], v[28:29], a[136:137], v[8:11]
  v_mfma_f32_16x16x16_bf16 v[12:15], v[28:29], a[138:139], v[12:15]
  v_mfma_f32_16x16x16_bf16 v[8:11], v[30:31], a[140:141], v[8:11]
  v_mfma_f32_16x16x16_bf16 v[12:15], v[30:31], a[142:143], v[12:15]
  buffer_load_dwordx4 a[240:243], v145, s[32:35], s51 offen offset:0 nt
  buffer_load_dwordx4 a[244:247], v145, s[32:35], s51 offen offset:1024 nt
  buffer_load_dwordx4 a[248:251], v145, s[32:35], s51 offen offset:2048 nt
  buffer_load_dwordx4 a[252:255], v145, s[32:35], s51 offen offset:3072 nt
  v_mul_f32 v182, v182, v5
  v_cvt_pk_bf16_f32 v182, v182, v182
  v_and_b32_dpp v24, v181, v3 quad_perm:[0,0,0,0] row_mask:0xf bank_mask:0xf
  v_and_b32_dpp v25, v181, v4 quad_perm:[0,0,0,0] row_mask:0xf bank_mask:0xf
  v_and_b32_dpp v26, v181, v3 quad_perm:[1,1,1,1] row_mask:0xf bank_mask:0xf
  v_and_b32_dpp v27, v181, v4 quad_perm:[1,1,1,1] row_mask:0xf bank_mask:0xf
  v_and_b32_dpp v28, v181, v3 quad_perm:[2,2,2,2] row_mask:0xf bank_mask:0xf
  v_and_b32_dpp v29, v181, v4 quad_perm:[2,2,2,2] row_mask:0xf bank_mask:0xf
  v_and_b32_dpp v30, v181, v3 quad_perm:[3,3,3,3] row_mask:0xf bank_mask:0xf
  v_and_b32_dpp v31, v181, v4 quad_perm:[3,3,3,3] row_mask:0xf bank_mask:0xf
  s_waitcnt vmcnt(28)
  v_mfma_f32_16x16x16_bf16 v[8:11], v[24:25], a[144:145], v[8:11]
  v_mfma_f32_16x16x16_bf16 v[12:15], v[24:25], a[146:147], v[12:15]
  v_mfma_f32_16x16x16_bf16 v[8:11], v[26:27], a[148:149], v[8:11]
  v_mfma_f32_16x16x16_bf16 v[12:15], v[26:27], a[150:151], v[12:15]
  v_mfma_f32_16x16x16_bf16 v[8:11], v[28:29], a[152:153], v[8:11]
  v_mfma_f32_16x16x16_bf16 v[12:15], v[28:29], a[154:155], v[12:15]
  v_mfma_f32_16x16x16_bf16 v[8:11], v[30:31], a[156:157], v[8:11]
  v_mfma_f32_16x16x16_bf16 v[12:15], v[30:31], a[158:159], v[12:15]
  v_mul_f32 v183, v183, v5
  v_cvt_pk_bf16_f32 v183, v183, v183
  v_and_b32_dpp v24, v182, v3 quad_perm:[0,0,0,0] row_mask:0xf bank_mask:0xf
  v_and_b32_dpp v25, v182, v4 quad_perm:[0,0,0,0] row_mask:0xf bank_mask:0xf
  v_and_b32_dpp v26, v182, v3 quad_perm:[1,1,1,1] row_mask:0xf bank_mask:0xf
  v_and_b32_dpp v27, v182, v4 quad_perm:[1,1,1,1] row_mask:0xf bank_mask:0xf
  v_and_b32_dpp v28, v182, v3 quad_perm:[2,2,2,2] row_mask:0xf bank_mask:0xf
  v_and_b32_dpp v29, v182, v4 quad_perm:[2,2,2,2] row_mask:0xf bank_mask:0xf
  v_and_b32_dpp v30, v182, v3 quad_perm:[3,3,3,3] row_mask:0xf bank_mask:0xf
  v_and_b32_dpp v31, v182, v4 quad_perm:[3,3,3,3] row_mask:0xf bank_mask:0xf
  s_waitcnt vmcnt(24)
  v_mfma_f32_16x16x16_bf16 v[8:11], v[24:25], a[160:161], v[8:11]
  v_mfma_f32_16x16x16_bf16 v[12:15], v[24:25], a[162:163], v[12:15]
  v_mfma_f32_16x16x16_bf16 v[8:11], v[26:27], a[164:165], v[8:11]
  v_mfma_f32_16x16x16_bf16 v[12:15], v[26:27], a[166:167], v[12:15]
  v_mfma_f32_16x16x16_bf16 v[8:11], v[28:29], a[168:169], v[8:11]
  v_mfma_f32_16x16x16_bf16 v[12:15], v[28:29], a[170:171], v[12:15]
  v_mfma_f32_16x16x16_bf16 v[8:11], v[30:31], a[172:173], v[8:11]
  v_mfma_f32_16x16x16_bf16 v[12:15], v[30:31], a[174:175], v[12:15]
  v_mul_f32 v184, v184, v5
  v_cvt_pk_bf16_f32 v184, v184, v184
  v_and_b32_dpp v24, v183, v3 quad_perm:[0,0,0,0] row_mask:0xf bank_mask:0xf
  v_and_b32_dpp v25, v183, v4 quad_perm:[0,0,0,0] row_mask:0xf bank_mask:0xf
  v_and_b32_dpp v26, v183, v3 quad_perm:[1,1,1,1] row_mask:0xf bank_mask:0xf
  v_and_b32_dpp v27, v183, v4 quad_perm:[1,1,1,1] row_mask:0xf bank_mask:0xf
  v_and_b32_dpp v28, v183, v3 quad_perm:[2,2,2,2] row_mask:0xf bank_mask:0xf
  v_and_b32_dpp v29, v183, v4 quad_perm:[2,2,2,2] row_mask:0xf bank_mask:0xf
  v_and_b32_dpp v30, v183, v3 quad_perm:[3,3,3,3] row_mask:0xf bank_mask:0xf
  v_and_b32_dpp v31, v183, v4 quad_perm:[3,3,3,3] row_mask:0xf bank_mask:0xf
  s_waitcnt vmcnt(20)
  v_mfma_f32_16x16x16_bf16 v[8:11], v[24:25], a[176:177], v[8:11]
  v_mfma_f32_16x16x16_bf16 v[12:15], v[24:25], a[178:179], v[12:15]
  v_mfma_f32_16x16x16_bf16 v[8:11], v[26:27], a[180:181], v[8:11]
  v_mfma_f32_16x16x16_bf16 v[12:15], v[26:27], a[182:183], v[12:15]
  v_mfma_f32_16x16x16_bf16 v[8:11], v[28:29], a[184:185], v[8:11]
  v_mfma_f32_16x16x16_bf16 v[12:15], v[28:29], a[186:187], v[12:15]
  v_mfma_f32_16x16x16_bf16 v[8:11], v[30:31], a[188:189], v[8:11]
  v_mfma_f32_16x16x16_bf16 v[12:15], v[30:31], a[190:191], v[12:15]
  v_mul_f32 v185, v185, v5
  v_cvt_pk_bf16_f32 v185, v185, v185
  v_and_b32_dpp v24, v184, v3 quad_perm:[0,0,0,0] row_mask:0xf bank_mask:0xf
  v_and_b32_dpp v25, v184, v4 quad_perm:[0,0,0,0] row_mask:0xf bank_mask:0xf
  v_and_b32_dpp v26, v184, v3 quad_perm:[1,1,1,1] row_mask:0xf bank_mask:0xf
  v_and_b32_dpp v27, v184, v4 quad_perm:[1,1,1,1] row_mask:0xf bank_mask:0xf
  v_and_b32_dpp v28, v184, v3 quad_perm:[2,2,2,2] row_mask:0xf bank_mask:0xf
  v_and_b32_dpp v29, v184, v4 quad_perm:[2,2,2,2] row_mask:0xf bank_mask:0xf
  v_and_b32_dpp v30, v184, v3 quad_perm:[3,3,3,3] row_mask:0xf bank_mask:0xf
  v_and_b32_dpp v31, v184, v4 quad_perm:[3,3,3,3] row_mask:0xf bank_mask:0xf
  s_waitcnt vmcnt(16)
  v_mfma_f32_16x16x16_bf16 v[8:11], v[24:25], a[192:193], v[8:11]
  v_mfma_f32_16x16x16_bf16 v[12:15], v[24:25], a[194:195], v[12:15]
  v_mfma_f32_16x16x16_bf16 v[8:11], v[26:27], a[196:197], v[8:11]
  v_mfma_f32_16x16x16_bf16 v[12:15], v[26:27], a[198:199], v[12:15]
  v_mfma_f32_16x16x16_bf16 v[8:11], v[28:29], a[200:201], v[8:11]
  v_mfma_f32_16x16x16_bf16 v[12:15], v[28:29], a[202:203], v[12:15]
  v_mfma_f32_16x16x16_bf16 v[8:11], v[30:31], a[204:205], v[8:11]
  v_mfma_f32_16x16x16_bf16 v[12:15], v[30:31], a[206:207], v[12:15]
  v_mul_f32 v186, v186, v5
  v_cvt_pk_bf16_f32 v186, v186, v186
  v_and_b32_dpp v24, v185, v3 quad_perm:[0,0,0,0] row_mask:0xf bank_mask:0xf
  v_and_b32_dpp v25, v185, v4 quad_perm:[0,0,0,0] row_mask:0xf bank_mask:0xf
  v_and_b32_dpp v26, v185, v3 quad_perm:[1,1,1,1] row_mask:0xf bank_mask:0xf
  v_and_b32_dpp v27, v185, v4 quad_perm:[1,1,1,1] row_mask:0xf bank_mask:0xf
  v_and_b32_dpp v28, v185, v3 quad_perm:[2,2,2,2] row_mask:0xf bank_mask:0xf
  v_and_b32_dpp v29, v185, v4 quad_perm:[2,2,2,2] row_mask:0xf bank_mask:0xf
  v_and_b32_dpp v30, v185, v3 quad_perm:[3,3,3,3] row_mask:0xf bank_mask:0xf
  v_and_b32_dpp v31, v185, v4 quad_perm:[3,3,3,3] row_mask:0xf bank_mask:0xf
  s_waitcnt vmcnt(12)
  v_mfma_f32_16x16x16_bf16 v[8:11], v[24:25], a[208:209], v[8:11]
  v_mfma_f32_16x16x16_bf16 v[12:15], v[24:25], a[210:211], v[12:15]
  v_mfma_f32_16x16x16_bf16 v[8:11], v[26:27], a[212:213], v[8:11]
  v_mfma_f32_16x16x16_bf16 v[12:15], v[26:27], a[214:215], v[12:15]
  v_mfma_f32_16x16x16_bf16 v[8:11], v[28:29], a[216:217], v[8:11]
  v_mfma_f32_16x16x16_bf16 v[12:15], v[28:29], a[218:219], v[12:15]
  v_mfma_f32_16x16x16_bf16 v[8:11], v[30:31], a[220:221], v[8:11]
  v_mfma_f32_16x16x16_bf16 v[12:15], v[30:31], a[222:223], v[12:15]
  v_mul_f32 v187, v187, v5
  v_cvt_pk_bf16_f32 v187, v187, v187
  v_and_b32_dpp v24, v186, v3 quad_perm:[0,0,0,0] row_mask:0xf bank_mask:0xf
  v_and_b32_dpp v25, v186, v4 quad_perm:[0,0,0,0] row_mask:0xf bank_mask:0xf
  v_and_b32_dpp v26, v186, v3 quad_perm:[1,1,1,1] row_mask:0xf bank_mask:0xf
  v_and_b32_dpp v27, v186, v4 quad_perm:[1,1,1,1] row_mask:0xf bank_mask:0xf
  v_and_b32_dpp v28, v186, v3 quad_perm:[2,2,2,2] row_mask:0xf bank_mask:0xf
  v_and_b32_dpp v29, v186, v4 quad_perm:[2,2,2,2] row_mask:0xf bank_mask:0xf
  v_and_b32_dpp v30, v186, v3 quad_perm:[3,3,3,3] row_mask:0xf bank_mask:0xf
  v_and_b32_dpp v31, v186, v4 quad_perm:[3,3,3,3] row_mask:0xf bank_mask:0xf
  s_waitcnt vmcnt(4)
  v_mfma_f32_16x16x16_bf16 v[8:11], v[24:25], a[224:225], v[8:11]
  v_mfma_f32_16x16x16_bf16 v[12:15], v[24:25], a[226:227], v[12:15]
  v_mfma_f32_16x16x16_bf16 v[8:11], v[26:27], a[228:229], v[8:11]
  v_mfma_f32_16x16x16_bf16 v[12:15], v[26:27], a[230:231], v[12:15]
  v_mfma_f32_16x16x16_bf16 v[8:11], v[28:29], a[232:233], v[8:11]
  v_mfma_f32_16x16x16_bf16 v[12:15], v[28:29], a[234:235], v[12:15]
  v_mfma_f32_16x16x16_bf16 v[8:11], v[30:31], a[236:237], v[8:11]
  v_mfma_f32_16x16x16_bf16 v[12:15], v[30:31], a[238:239], v[12:15]
  v_and_b32_dpp v24, v187, v3 quad_perm:[0,0,0,0] row_mask:0xf bank_mask:0xf
  v_and_b32_dpp v25, v187, v4 quad_perm:[0,0,0,0] row_mask:0xf bank_mask:0xf
  v_and_b32_dpp v26, v187, v3 quad_perm:[1,1,1,1] row_mask:0xf bank_mask:0xf
  v_and_b32_dpp v27, v187, v4 quad_perm:[1,1,1,1] row_mask:0xf bank_mask:0xf
  v_and_b32_dpp v28, v187, v3 quad_perm:[2,2,2,2] row_mask:0xf bank_mask:0xf
  v_and_b32_dpp v29, v187, v4 quad_perm:[2,2,2,2] row_mask:0xf bank_mask:0xf
  v_and_b32_dpp v30, v187, v3 quad_perm:[3,3,3,3] row_mask:0xf bank_mask:0xf
  v_and_b32_dpp v31, v187, v4 quad_perm:[3,3,3,3] row_mask:0xf bank_mask:0xf
  s_waitcnt vmcnt(3)
  v_mfma_f32_16x16x16_bf16 v[8:11], v[24:25], a[240:241], v[8:11]
  v_mfma_f32_16x16x16_bf16 v[12:15], v[24:25], a[242:243], v[12:15]
  s_waitcnt vmcnt(2)
  v_mfma_f32_16x16x16_bf16 v[8:11], v[26:27], a[244:245], v[8:11]
  v_mfma_f32_16x16x16_bf16 v[12:15], v[26:27], a[246:247], v[12:15]
  s_waitcnt vmcnt(1)
  v_mfma_f32_16x16x16_bf16 v[8:11], v[28:29], a[248:249], v[8:11]
  v_mfma_f32_16x16x16_bf16 v[12:15], v[28:29], a[250:251], v[12:15]
  s_waitcnt vmcnt(0)
  v_mfma_f32_16x16x16_bf16 v[8:11], v[30:31], a[252:253], v[8:11]
  v_mfma_f32_16x16x16_bf16 v[12:15], v[30:31], a[254:255], v[12:15]
  buffer_load_dwordx4 v[108:111], v61, s[44:47], s53 offen nt
  s_add_u32 s53, s53, 131072
  buffer_load_dwordx4 v[112:115], v61, s[44:47], s53 offen nt
  s_add_u32 s53, s53, 131072
  buffer_load_dwordx4 v[116:119], v61, s[44:47], s53 offen nt
  s_add_u32 s53, s53, 131072
  buffer_load_dwordx4 v[120:123], v61, s[44:47], s53 offen nt
  global_load_ushort v132, v133, s[4:5]
  buffer_load_dword v105, v106, s[40:43], s15 offen
  ds_write_b128 v53, v[8:11] offset:4608
  ds_write_b128 v188, v[12:15] offset:4608
  ds_add_rtn_u32 v63, v189, v190 offset:18944
  ds_read_b128 v[64:67], v54 offset:4608
  ds_read_b128 v[68:71], v54 offset:6656
  ds_read_b128 v[72:75], v54 offset:8704
  ds_read_b128 v[76:79], v54 offset:10752
  ds_read_b128 v[80:83], v54 offset:5632
  ds_read_b128 v[84:87], v54 offset:7680
  ds_read_b128 v[88:91], v54 offset:9728
  ds_read_b128 v[92:95], v54 offset:11776
  s_cmp_eq_u32 s58, 0
  s_waitcnt lgkmcnt(8)
  v_cmp_eq_u32 vcc, 3, v63
  s_cbranch_vccz L_notlast
  s_waitcnt lgkmcnt(6)
  v_pk_add_f32 v[64:65], v[64:65], v[68:69]
  v_pk_add_f32 v[66:67], v[66:67], v[70:71]
  s_waitcnt lgkmcnt(5)
  v_pk_add_f32 v[64:65], v[64:65], v[72:73]
  v_pk_add_f32 v[66:67], v[66:67], v[74:75]
  s_waitcnt lgkmcnt(4)
  v_pk_add_f32 v[64:65], v[64:65], v[76:77]
  v_pk_add_f32 v[66:67], v[66:67], v[78:79]
  v_bfi_b32 v8, v52, s64, v64
  v_bfi_b32 v9, v52, s65, v65
  v_bfi_b32 v10, v52, s66, v66
  v_bfi_b32 v11, v52, s67, v67
  s_cbranch_scc1 L_p0slow
  buffer_store_dwordx4 v[8:11], v2, s[40:43], s75 offen offset:0
L_p0done:
  s_waitcnt lgkmcnt(2)
  v_pk_add_f32 v[80:81], v[80:81], v[84:85]
  v_pk_add_f32 v[82:83], v[82:83], v[86:87]
  s_waitcnt lgkmcnt(1)
  v_pk_add_f32 v[80:81], v[80:81], v[88:89]
  v_pk_add_f32 v[82:83], v[82:83], v[90:91]
  s_waitcnt lgkmcnt(0)
  v_pk_add_f32 v[80:81], v[80:81], v[92:93]
  v_pk_add_f32 v[82:83], v[82:83], v[94:95]
  v_bfi_b32 v12, v52, s64, v80
  v_bfi_b32 v13, v52, s65, v81
  v_bfi_b32 v14, v52, s66, v82
  v_bfi_b32 v15, v52, s67, v83
  s_cbranch_scc1 L_p1slow
  buffer_store_dwordx4 v[12:15], v2, s[40:43], s75 offen offset:1024
L_p1done:
L_notlast:
  s_waitcnt lgkmcnt(0)
L_apoll:
  buffer_load_dwordx4 v[64:67], v57, s[40:43], s24 offen sc1
  buffer_load_dwordx4 v[68:71], v57, s[40:43], s25 offen sc1
  s_waitcnt vmcnt(1)
  v_xor_b32 v64, s64, v64
  v_xor_b32 v65, s65, v65
  v_xor_b32 v66, s66, v66
  v_xor_b32 v67, s67, v67
  v_or3_b32 v7, v64, v65, v66
  s_waitcnt vmcnt(0)
  v_xor_b32 v68, s64, v68
  v_xor_b32 v69, s65, v69
  v_xor_b32 v70, s66, v70
  v_xor_b32 v71, s67, v71
  v_or3_b32 v7, v7, v67, v68
  v_or3_b32 v63, v69, v70, v71
  v_or_b32 v7, v7, v63
  v_and_b32 v7, v52, v7
  v_cmp_ne_u32 vcc, 0, v7
  s_cbranch_vccz L_aok
  s_mov_b64 exec, vcc
  s_sub_u32 s70, s70, 1
  s_cmp_gt_i32 s70, 0
  s_cbranch_scc1 L_apoll
L_aok:
  s_mov_b64 exec, -1
  v_pk_add_f32 v[64:65], v[64:65], v[68:69]
  v_pk_add_f32 v[66:67], v[66:67], v[70:71]
  s_nop 0
  v_permlane32_swap_b32 v64, v65
  v_permlane32_swap_b32 v66, v67
  v_add_f32 v64, v64, v65
  v_add_f32 v66, v66, v67
  s_nop 1
  v_permlane16_swap_b32 v64, v66
  v_add_f32 v64, v64, v66
  s_nop 1
  v_add_f32_dpp v64, v64, v64 row_ror:8 row_mask:0xf bank_mask:0xf
  s_nop 1
  v_add_f32_dpp v64, v64, v64 row_ror:4 row_mask:0xf bank_mask:0xf
  v_cvt_pk_bf16_f32 v64, v64, v64
  s_nop 1
  v_and_b32_dpp v32, v64, v124 quad_perm:[0,0,0,0] row_mask:0xf bank_mask:0xf
  v_and_b32_dpp v33, v64, v125 quad_perm:[0,0,0,0] row_mask:0xf bank_mask:0xf
  v_and_b32_dpp v34, v64, v126 quad_perm:[0,0,0,0] row_mask:0xf bank_mask:0xf
  v_and_b32_dpp v35, v64, v127 quad_perm:[0,0,0,0] row_mask:0xf bank_mask:0xf
  v_and_b32_dpp v36, v64, v124 quad_perm:[1,1,1,1] row_mask:0xf bank_mask:0xf
  v_and_b32_dpp v37, v64, v125 quad_perm:[1,1,1,1] row_mask:0xf bank_mask:0xf
  v_and_b32_dpp v38, v64, v126 quad_perm:[1,1,1,1] row_mask:0xf bank_mask:0xf
  v_and_b32_dpp v39, v64, v127 quad_perm:[1,1,1,1] row_mask:0xf bank_mask:0xf
  v_mfma_f32_16x16x32_bf16 v[20:23], v[32:35], v[108:111], 0
  v_and_b32_dpp v40, v64, v124 quad_perm:[2,2,2,2] row_mask:0xf bank_mask:0xf
  v_and_b32_dpp v41, v64, v125 quad_perm:[2,2,2,2] row_mask:0xf bank_mask:0xf
  v_and_b32_dpp v42, v64, v126 quad_perm:[2,2,2,2] row_mask:0xf bank_mask:0xf
  v_and_b32_dpp v43, v64, v127 quad_perm:[2,2,2,2] row_mask:0xf bank_mask:0xf
  v_mfma_f32_16x16x32_bf16 v[20:23], v[36:39], v[112:115], v[20:23]
  v_and_b32_dpp v44, v64, v124 quad_perm:[3,3,3,3] row_mask:0xf bank_mask:0xf
  v_and_b32_dpp v45, v64, v125 quad_perm:[3,3,3,3] row_mask:0xf bank_mask:0xf
  v_and_b32_dpp v46, v64, v126 quad_perm:[3,3,3,3] row_mask:0xf bank_mask:0xf
  v_and_b32_dpp v47, v64, v127 quad_perm:[3,3,3,3] row_mask:0xf bank_mask:0xf
  v_mfma_f32_16x16x32_bf16 v[20:23], v[40:43], v[116:119], v[20:23]
  s_nop 0
  v_mfma_f32_16x16x32_bf16 v[20:23], v[44:47], v[120:123], v[20:23]
  s_mov_b32 exec_hi, 0
  s_nop 6
  ds_write_b128 v59, v[20:23] offset:12800
  s_mov_b32 exec_hi, -1
  s_waitcnt lgkmcnt(0)
  s_barrier
  ds_read2st64_b32 v[16:17], v191 offset0:0 offset1:2
  ds_read2st64_b32 v[18:19], v191 offset0:4 offset1:6
  s_waitcnt lgkmcnt(0)
  v_pk_add_f32 v[16:17], v[16:17], v[18:19]
  v_add_f32 v16, v16, v17
  v_cndmask_b32 v16, v16, 1.0, s[6:7]
  v_cvt_f64_f32 v[20:21], v16
  buffer_atomic_add_f64 v[20:21], v107, s[40:43], s77 offen sc0 sc1
  v_cvt_f64_f32 v[22:23], v16
  v_and_b32 v63, 2, v0
  v_lshlrev_b32 v63, 3, v63
  v_lshrrev_b32 v63, v63, s55
L_gchk:
  v_xor_b32 v7, v63, v105
  v_and_b32 v7, 0xffff, v7
  v_cmp_ne_u32 vcc, 0, v7
  s_cbranch_vccnz L_gretry
L_gok:
  v_and_b32 v105, s68, v105
  v_lshlrev_b32 v132, 16, v132
  s_mov_b32 s60, 0x42800000
  s_waitcnt vmcnt(0)
  v_add_f64 v[20:21], v[20:21], v[22:23]
  v_cvt_f32_f64 v16, v[20:21]
  v_cmp_eq_f32 vcc, s60, v16
  v_cvt_pk_bf16_f32 v16, v16, v16
  v_and_b32 v16, s68, v16
  v_mul_f32 v16, v16, v105
  v_cvt_pk_bf16_f32 v16, v16, v16
  v_and_b32 v16, s68, v16
  v_add_f32 v16, v16, v132
  v_cvt_pk_bf16_f32 v16, v16, v16
  s_and_b64 vcc, vcc, s[6:7]
  s_lshr_b64 exec, vcc, 1
  s_cbranch_execz L_fin
  global_store_short v133, v16, s[22:23]
  s_cmp_lg_u32 s77, 262144
  s_cbranch_scc1 L_fin
  s_bitcmp0_b32 exec_lo, 0
  s_cbranch_scc1 L_fin
  s_mov_b64 exec, 1
  v_mov_b32 v7, s55
  buffer_store_dword v7, v2, s[40:43], 0 offen
L_fin:
L_done:
  s_endpgm
L_qretry:
  s_sub_u32 s70, s70, 1
  s_cmp_le_i32 s70, 0
  s_cbranch_scc1 L_qok
  buffer_load_dwordx4 v[64:67], v57, s[40:43], s53 offen offset:0 sc1
  buffer_load_dwordx4 v[68:71], v57, s[40:43], s53 offen offset:16 sc1
  buffer_load_dwordx4 v[72:75], v57, s[40:43], s3 offen offset:0 sc1
  buffer_load_dwordx4 v[76:79], v57, s[40:43], s3 offen offset:16 sc1
  buffer_load_dwordx2 v[136:137], v58, s[40:43], s24 offen sc1
  buffer_load_dwordx2 v[138:139], v58, s[40:43], s25 offen sc1
  buffer_load_dwordx2 v[140:141], v58, s[40:43], s60 offen sc1
  buffer_load_dwordx2 v[142:143], v58, s[40:43], s61 offen sc1
  s_waitcnt vmcnt(0)
  s_branch L_qchk
L_vs22:
  buffer_load_dwordx2 a[96:97], v146, s[28:31], s51 offen offset:0 nt
  buffer_load_dwordx2 a[98:99], v146, s[28:31], s51 offen offset:8 nt
  buffer_load_dwordx2 a[100:101], v146, s[28:31], s51 offen offset:128 nt
  buffer_load_dwordx2 a[102:103], v146, s[28:31], s51 offen offset:136 nt
  buffer_load_dwordx2 a[104:105], v146, s[28:31], s51 offen offset:2048 nt
  buffer_load_dwordx2 a[106:107], v146, s[28:31], s51 offen offset:2056 nt
  buffer_load_dwordx2 a[108:109], v146, s[28:31], s51 offen offset:2176 nt
  buffer_load_dwordx2 a[110:111], v146, s[28:31], s51 offen offset:2184 nt
  s_branch L_vj22
L_vs24:
  buffer_load_dwordx2 a[128:129], v146, s[28:31], s51 offen offset:0 nt
  buffer_load_dwordx2 a[130:131], v146, s[28:31], s51 offen offset:8 nt
  buffer_load_dwordx2 a[132:133], v146, s[28:31], s51 offen offset:128 nt
  buffer_load_dwordx2 a[134:135], v146, s[28:31], s51 offen offset:136 nt
  buffer_load_dwordx2 a[136:137], v146, s[28:31], s51 offen offset:2048 nt
  buffer_load_dwordx2 a[138:139], v146, s[28:31], s51 offen offset:2056 nt
  buffer_load_dwordx2 a[140:141], v146, s[28:31], s51 offen offset:2176 nt
  buffer_load_dwordx2 a[142:143], v146, s[28:31], s51 offen offset:2184 nt
  s_branch L_vj24
L_vs26:
  buffer_load_dwordx2 a[160:161], v146, s[28:31], s51 offen offset:0 nt
  buffer_load_dwordx2 a[162:163], v146, s[28:31], s51 offen offset:8 nt
  buffer_load_dwordx2 a[164:165], v146, s[28:31], s51 offen offset:128 nt
  buffer_load_dwordx2 a[166:167], v146, s[28:31], s51 offen offset:136 nt
  buffer_load_dwordx2 a[168:169], v146, s[28:31], s51 offen offset:2048 nt
  buffer_load_dwordx2 a[170:171], v146, s[28:31], s51 offen offset:2056 nt
  buffer_load_dwordx2 a[172:173], v146, s[28:31], s51 offen offset:2176 nt
  buffer_load_dwordx2 a[174:175], v146, s[28:31], s51 offen offset:2184 nt
  s_branch L_vj26
L_vs28:
  buffer_load_dwordx2 a[192:193], v146, s[28:31], s51 offen offset:0 nt
  buffer_load_dwordx2 a[194:195], v146, s[28:31], s51 offen offset:8 nt
  buffer_load_dwordx2 a[196:197], v146, s[28:31], s51 offen offset:128 nt
  buffer_load_dwordx2 a[198:199], v146, s[28:31], s51 offen offset:136 nt
  buffer_load_dwordx2 a[200:201], v146, s[28:31], s51 offen offset:2048 nt
  buffer_load_dwordx2 a[202:203], v146, s[28:31], s51 offen offset:2056 nt
  buffer_load_dwordx2 a[204:205], v146, s[28:31], s51 offen offset:2176 nt
  buffer_load_dwordx2 a[206:207], v146, s[28:31], s51 offen offset:2184 nt
  s_branch L_vj28
L_vs30:
  buffer_load_dwordx2 a[224:225], v146, s[28:31], s51 offen offset:0 nt
  buffer_load_dwordx2 a[226:227], v146, s[28:31], s51 offen offset:8 nt
  buffer_load_dwordx2 a[228:229], v146, s[28:31], s51 offen offset:128 nt
  buffer_load_dwordx2 a[230:231], v146, s[28:31], s51 offen offset:136 nt
  buffer_load_dwordx2 a[232:233], v146, s[28:31], s51 offen offset:2048 nt
  buffer_load_dwordx2 a[234:235], v146, s[28:31], s51 offen offset:2056 nt
  buffer_load_dwordx2 a[236:237], v146, s[28:31], s51 offen offset:2176 nt
  buffer_load_dwordx2 a[238:239], v146, s[28:31], s51 offen offset:2184 nt
  s_branch L_vj30
L_yslow:
  buffer_store_dwordx4 v[64:67], v2, s[40:43], s56 offen sc1
  s_branch L_ydone
L_mlslow:
  buffer_store_dwordx4 v[12:15], v2, s[40:43], s76 offen sc1
  s_branch L_mldone
L_vs41:
  buffer_load_dwordx2 a[144:145], v145, s[32:35], s51 offen offset:0 nt
  buffer_load_dwordx2 a[146:147], v145, s[32:35], s51 offen offset:8 nt
  buffer_load_dwordx2 a[148:149], v145, s[32:35], s51 offen offset:1024 nt
  buffer_load_dwordx2 a[150:151], v145, s[32:35], s51 offen offset:1032 nt
  buffer_load_dwordx2 a[152:153], v145, s[32:35], s51 offen offset:2048 nt
  buffer_load_dwordx2 a[154:155], v145, s[32:35], s51 offen offset:2056 nt
  buffer_load_dwordx2 a[156:157], v145, s[32:35], s51 offen offset:3072 nt
  buffer_load_dwordx2 a[158:159], v145, s[32:35], s51 offen offset:3080 nt
  s_branch L_vj41
L_vs43:
  buffer_load_dwordx2 a[176:177], v145, s[32:35], s51 offen offset:0 nt
  buffer_load_dwordx2 a[178:179], v145, s[32:35], s51 offen offset:8 nt
  buffer_load_dwordx2 a[180:181], v145, s[32:35], s51 offen offset:1024 nt
  buffer_load_dwordx2 a[182:183], v145, s[32:35], s51 offen offset:1032 nt
  buffer_load_dwordx2 a[184:185], v145, s[32:35], s51 offen offset:2048 nt
  buffer_load_dwordx2 a[186:187], v145, s[32:35], s51 offen offset:2056 nt
  buffer_load_dwordx2 a[188:189], v145, s[32:35], s51 offen offset:3072 nt
  buffer_load_dwordx2 a[190:191], v145, s[32:35], s51 offen offset:3080 nt
  s_branch L_vj43
L_vs44:
  buffer_load_dwordx2 a[192:193], v145, s[32:35], s51 offen offset:0 nt
  buffer_load_dwordx2 a[194:195], v145, s[32:35], s51 offen offset:8 nt
  buffer_load_dwordx2 a[196:197], v145, s[32:35], s51 offen offset:1024 nt
  buffer_load_dwordx2 a[198:199], v145, s[32:35], s51 offen offset:1032 nt
  buffer_load_dwordx2 a[200:201], v145, s[32:35], s51 offen offset:2048 nt
  buffer_load_dwordx2 a[202:203], v145, s[32:35], s51 offen offset:2056 nt
  buffer_load_dwordx2 a[204:205], v145, s[32:35], s51 offen offset:3072 nt
  buffer_load_dwordx2 a[206:207], v145, s[32:35], s51 offen offset:3080 nt
  s_branch L_vj44
L_vs45:
  buffer_load_dwordx2 a[208:209], v145, s[32:35], s51 offen offset:0 nt
  buffer_load_dwordx2 a[210:211], v145, s[32:35], s51 offen offset:8 nt
  buffer_load_dwordx2 a[212:213], v145, s[32:35], s51 offen offset:1024 nt
  buffer_load_dwordx2 a[214:215], v145, s[32:35], s51 offen offset:1032 nt
  buffer_load_dwordx2 a[216:217], v145, s[32:35], s51 offen offset:2048 nt
  buffer_load_dwordx2 a[218:219], v145, s[32:35], s51 offen offset:2056 nt
  buffer_load_dwordx2 a[220:221], v145, s[32:35], s51 offen offset:3072 nt
  buffer_load_dwordx2 a[222:223], v145, s[32:35], s51 offen offset:3080 nt
  s_branch L_vj45
L_vs46:
  buffer_load_dwordx2 a[224:225], v145, s[32:35], s51 offen offset:0 nt
  buffer_load_dwordx2 a[226:227], v145, s[32:35], s51 offen offset:8 nt
  buffer_load_dwordx2 a[228:229], v145, s[32:35], s51 offen offset:1024 nt
  buffer_load_dwordx2 a[230:231], v145, s[32:35], s51 offen offset:1032 nt
  buffer_load_dwordx2 a[232:233], v145, s[32:35], s51 offen offset:2048 nt
  buffer_load_dwordx2 a[234:235], v145, s[32:35], s51 offen offset:2056 nt
  buffer_load_dwordx2 a[236:237], v145, s[32:35], s51 offen offset:3072 nt
  buffer_load_dwordx2 a[238:239], v145, s[32:35], s51 offen offset:3080 nt
  s_branch L_vj46
L_vs47:
  buffer_load_dwordx2 a[240:241], v145, s[32:35], s51 offen offset:0 nt
  buffer_load_dwordx2 a[242:243], v145, s[32:35], s51 offen offset:8 nt
  buffer_load_dwordx2 a[244:245], v145, s[32:35], s51 offen offset:1024 nt
  buffer_load_dwordx2 a[246:247], v145, s[32:35], s51 offen offset:1032 nt
  buffer_load_dwordx2 a[248:249], v145, s[32:35], s51 offen offset:2048 nt
  buffer_load_dwordx2 a[250:251], v145, s[32:35], s51 offen offset:2056 nt
  buffer_load_dwordx2 a[252:253], v145, s[32:35], s51 offen offset:3072 nt
  buffer_load_dwordx2 a[254:255], v145, s[32:35], s51 offen offset:3080 nt
  s_branch L_vj47
L_mretry:
  s_sub_u32 s70, s70, 1
  s_cmp_le_i32 s70, 0
  s_cbranch_scc1 L_mok
  buffer_load_dwordx4 v[64:67], v58, s[40:43], s3 offen sc1
  buffer_load_dwordx4 v[68:71], v58, s[40:43], s3 offen offset:1024 sc1
  s_waitcnt vmcnt(0)
  s_branch L_mchk
L_yretry:
  s_sub_u32 s70, s70, 1
  s_cmp_le_i32 s70, 0
  s_cbranch_scc1 L_yok
  s_add_u32 s56, s73, 0
  buffer_load_dwordx4 v[32:35], v60, s[40:43], s56 offen sc1
  s_add_u32 s56, s73, 16384
  buffer_load_dwordx4 v[36:39], v60, s[40:43], s56 offen sc1
  s_add_u32 s56, s73, 32768
  buffer_load_dwordx4 v[40:43], v60, s[40:43], s56 offen sc1
  s_mov_b32 exec_hi, 0
  s_add_u32 s56, s73, 49152
  buffer_load_dwordx4 v[44:47], v60, s[40:43], s56 offen sc1
  s_mov_b64 exec, -1
  s_waitcnt vmcnt(0)
  s_branch L_ychk
L_vs56:
  buffer_load_dwordx2 a[128:129], v145, s[32:35], s51 offen offset:0 nt
  buffer_load_dwordx2 a[130:131], v145, s[32:35], s51 offen offset:8 nt
  buffer_load_dwordx2 a[132:133], v145, s[32:35], s51 offen offset:1024 nt
  buffer_load_dwordx2 a[134:135], v145, s[32:35], s51 offen offset:1032 nt
  buffer_load_dwordx2 a[136:137], v145, s[32:35], s51 offen offset:2048 nt
  buffer_load_dwordx2 a[138:139], v145, s[32:35], s51 offen offset:2056 nt
  buffer_load_dwordx2 a[140:141], v145, s[32:35], s51 offen offset:3072 nt
  buffer_load_dwordx2 a[142:143], v145, s[32:35], s51 offen offset:3080 nt
  s_branch L_vj56
L_vs57:
  buffer_load_dwordx2 a[144:145], v145, s[32:35], s51 offen offset:0 nt
  buffer_load_dwordx2 a[146:147], v145, s[32:35], s51 offen offset:8 nt
  buffer_load_dwordx2 a[148:149], v145, s[32:35], s51 offen offset:1024 nt
  buffer_load_dwordx2 a[150:151], v145, s[32:35], s51 offen offset:1032 nt
  buffer_load_dwordx2 a[152:153], v145, s[32:35], s51 offen offset:2048 nt
  buffer_load_dwordx2 a[154:155], v145, s[32:35], s51 offen offset:2056 nt
  buffer_load_dwordx2 a[156:157], v145, s[32:35], s51 offen offset:3072 nt
  buffer_load_dwordx2 a[158:159], v145, s[32:35], s51 offen offset:3080 nt
  s_branch L_vj57
L_vs58:
  buffer_load_dwordx2 a[160:161], v145, s[32:35], s51 offen offset:0 nt
  buffer_load_dwordx2 a[162:163], v145, s[32:35], s51 offen offset:8 nt
  buffer_load_dwordx2 a[164:165], v145, s[32:35], s51 offen offset:1024 nt
  buffer_load_dwordx2 a[166:167], v145, s[32:35], s51 offen offset:1032 nt
  buffer_load_dwordx2 a[168:169], v145, s[32:35], s51 offen offset:2048 nt
  buffer_load_dwordx2 a[170:171], v145, s[32:35], s51 offen offset:2056 nt
  buffer_load_dwordx2 a[172:173], v145, s[32:35], s51 offen offset:3072 nt
  buffer_load_dwordx2 a[174:175], v145, s[32:35], s51 offen offset:3080 nt
  s_branch L_vj58
L_vs59:
  buffer_load_dwordx2 a[176:177], v145, s[32:35], s51 offen offset:0 nt
  buffer_load_dwordx2 a[178:179], v145, s[32:35], s51 offen offset:8 nt
  buffer_load_dwordx2 a[180:181], v145, s[32:35], s51 offen offset:1024 nt
  buffer_load_dwordx2 a[182:183], v145, s[32:35], s51 offen offset:1032 nt
  buffer_load_dwordx2 a[184:185], v145, s[32:35], s51 offen offset:2048 nt
  buffer_load_dwordx2 a[186:187], v145, s[32:35], s51 offen offset:2056 nt
  buffer_load_dwordx2 a[188:189], v145, s[32:35], s51 offen offset:3072 nt
  buffer_load_dwordx2 a[190:191], v145, s[32:35], s51 offen offset:3080 nt
  s_branch L_vj59
L_vs60:
  buffer_load_dwordx2 a[192:193], v145, s[32:35], s51 offen offset:0 nt
  buffer_load_dwordx2 a[194:195], v145, s[32:35], s51 offen offset:8 nt
  buffer_load_dwordx2 a[196:197], v145, s[32:35], s51 offen offset:1024 nt
  buffer_load_dwordx2 a[198:199], v145, s[32:35], s51 offen offset:1032 nt
  buffer_load_dwordx2 a[200:201], v145, s[32:35], s51 offen offset:2048 nt
  buffer_load_dwordx2 a[202:203], v145, s[32:35], s51 offen offset:2056 nt
  buffer_load_dwordx2 a[204:205], v145, s[32:35], s51 offen offset:3072 nt
  buffer_load_dwordx2 a[206:207], v145, s[32:35], s51 offen offset:3080 nt
  s_branch L_vj60
L_vs61:
  buffer_load_dwordx2 a[208:209], v145, s[32:35], s51 offen offset:0 nt
  buffer_load_dwordx2 a[210:211], v145, s[32:35], s51 offen offset:8 nt
  buffer_load_dwordx2 a[212:213], v145, s[32:35], s51 offen offset:1024 nt
  buffer_load_dwordx2 a[214:215], v145, s[32:35], s51 offen offset:1032 nt
  buffer_load_dwordx2 a[216:217], v145, s[32:35], s51 offen offset:2048 nt
  buffer_load_dwordx2 a[218:219], v145, s[32:35], s51 offen offset:2056 nt
  buffer_load_dwordx2 a[220:221], v145, s[32:35], s51 offen offset:3072 nt
  buffer_load_dwordx2 a[222:223], v145, s[32:35], s51 offen offset:3080 nt
  s_branch L_vj61
L_p0slow:
  buffer_store_dwordx4 v[8:11], v2, s[40:43], s75 offen offset:0 sc1
  s_branch L_p0done
L_p1slow:
  buffer_store_dwordx4 v[12:15], v2, s[40:43], s75 offen offset:1024 sc1
  s_branch L_p1done
L_gretry:
  s_sub_u32 s70, s70, 1
  s_cmp_le_i32 s70, 0
  s_cbranch_scc1 L_gok
  buffer_load_dword v105, v106, s[40:43], s15 offen sc1
  s_waitcnt vmcnt(0)
  s_branch L_gchk
L_codeend:
.section .rodata,"a"
.p2align 6
.amdhsa_kernel recurrent_scan__gqa_block_cached__glu_gated_glu__decode_kernel
  .amdhsa_next_free_vgpr 448
  .amdhsa_next_free_sgpr 102
  .amdhsa_accum_offset 192
  .amdhsa_group_segment_fixed_size 0
  .amdhsa_kernarg_size 96
  .amdhsa_user_sgpr_count 2
  .amdhsa_user_sgpr_kernarg_segment_ptr 1
  .amdhsa_system_sgpr_workgroup_id_x 1
  .amdhsa_float_denorm_mode_32 3
.end_amdhsa_kernel
```
